```python
import torch

def _softmax(x, axis=-1):
    return torch.softmax(x, dim=axis)
def _gelu(x):
    return torch.nn.functional.gelu(x, approximate="tanh")
def _silu(x):
    return torch.nn.functional.silu(x)
def _sigmoid(x):
    return torch.sigmoid(x)
def _layernorm(x, axis=-1, eps=1e-5):
    m = x.mean(dim=axis, keepdim=True)
    v = x.var(dim=axis, keepdim=True, unbiased=False)
    return (x - m) / torch.sqrt(v + eps)
def _scatter_add(tgt, idx, src, axis=0):
    return tgt.clone().index_add_(axis, idx, src)
def _segment_sum(src, seg, n):
    out = torch.zeros((n,) + src.shape[1:], dtype=src.dtype)
    return out.index_add_(0, seg, src)
def _pad(x, pw):
    flat = tuple(v for pair in reversed(pw) for v in pair)
    return torch.nn.functional.pad(x, flat)

kernel_name = 'concat_heads__gqa_block_cached__gqa_block_cached__decode'

def setup_inputs():

    _w = (lambda a: (lambda t: t.to(torch.bfloat16) if t.is_floating_point() else t)(torch.as_tensor(a)))
    def _A_setup():
        B, Sq, D = 4, 1, 512
        Hq, Hkv, Sk, Dh = 32, 8, 16384, 128
        assert Hq % Hkv == 0, (Hq, Hkv)
        return {
            "x": _w((lambda *s: torch.randn(*s, dtype=torch.bfloat16) * 0.8)(B, Sq, D)),
            "k_cache": _w((lambda *s: torch.randn(*s, dtype=torch.bfloat16) * 0.8)(B, Hkv, Sk, Dh)),
            "v_cache": _w((lambda *s: torch.randn(*s, dtype=torch.bfloat16) * 0.05)(B, Hkv, Sk, Dh)),
            "wq": _w((lambda *s: torch.randn(*s, dtype=torch.bfloat16) * 0.8)(D, Hq * Dh) * (D ** -0.5)),
            "wo": _w((lambda *s: torch.randn(*s, dtype=torch.bfloat16) * 0.05)(Hq * Dh, D) * ((Hq * Dh) ** -0.5)),
        }
    _A_in = _A_setup()

    def _B_setup():
        B, Sq, D = 4, 1, 512
        Hq, Hkv, Sk, Dh = 32, 8, 16384, 128
        assert Hq % Hkv == 0, (Hq, Hkv)
        return {
            "x": _w((lambda *s: torch.randn(*s, dtype=torch.bfloat16) * 0.8)(B, Sq, D)),
            "k_cache": _w((lambda *s: torch.randn(*s, dtype=torch.bfloat16) * 0.8)(B, Hkv, Sk, Dh)),
            "v_cache": _w((lambda *s: torch.randn(*s, dtype=torch.bfloat16) * 0.05)(B, Hkv, Sk, Dh)),
            "wq": _w((lambda *s: torch.randn(*s, dtype=torch.bfloat16) * 0.8)(D, Hq * Dh) * (D ** -0.5)),
            "wo": _w((lambda *s: torch.randn(*s, dtype=torch.bfloat16) * 0.05)(Hq * Dh, D) * ((Hq * Dh) ** -0.5)),
        }
    _B_in = _B_setup()

    return {
        "A_x": _A_in["x"],
        "A_k_cache": _A_in["k_cache"],
        "A_v_cache": _A_in["v_cache"],
        "A_wq": _A_in["wq"],
        "A_wo": _A_in["wo"],
        "B_x": _B_in["x"],
        "B_k_cache": _B_in["k_cache"],
        "B_v_cache": _B_in["v_cache"],
        "B_wq": _B_in["wq"],
        "B_wo": _B_in["wo"],
    }

def reference(A_x, A_k_cache, A_v_cache, A_wq, A_wo, B_x, B_k_cache, B_v_cache, B_wq, B_wo):
    def _A_ref(x, k_cache, v_cache, wq, wo):
        B, Sq, D = x.shape
        Hq, Dh = 32, 128
        Hkv = k_cache.shape[1]
        rep = Hq // Hkv
        q = (lambda x, *d: x.permute(*d))((x @ wq).reshape(B, Sq, Hq, Dh), 0, 2, 1, 3)
        k = (lambda x, n, axis: torch.repeat_interleave(x, n, dim=axis))(k_cache, rep, axis=1)
        v = (lambda x, n, axis: torch.repeat_interleave(x, n, dim=axis))(v_cache, rep, axis=1)
        scores = torch.einsum("bhqd,bhkd->bhqk", q, k) * (Dh ** -0.5)
        p = _softmax(scores, axis=-1)
        o = torch.einsum("bhqk,bhkd->bhqd", p, v)
        return (lambda x, *d: x.permute(*d))(o, 0, 2, 1, 3).reshape(B, Sq, Hq * Dh) @ wo

    def _B_ref(x, k_cache, v_cache, wq, wo):
        B, Sq, D = x.shape
        Hq, Dh = 32, 128
        Hkv = k_cache.shape[1]
        rep = Hq // Hkv
        q = (lambda x, *d: x.permute(*d))((x @ wq).reshape(B, Sq, Hq, Dh), 0, 2, 1, 3)
        k = (lambda x, n, axis: torch.repeat_interleave(x, n, dim=axis))(k_cache, rep, axis=1)
        v = (lambda x, n, axis: torch.repeat_interleave(x, n, dim=axis))(v_cache, rep, axis=1)
        scores = torch.einsum("bhqd,bhkd->bhqk", q, k) * (Dh ** -0.5)
        p = _softmax(scores, axis=-1)
        o = torch.einsum("bhqk,bhkd->bhqd", p, v)
        return (lambda x, *d: x.permute(*d))(o, 0, 2, 1, 3).reshape(B, Sq, Hq * Dh) @ wo

    a = _A_ref(A_x, A_k_cache, A_v_cache, A_wq, A_wo)
    b = _B_ref(B_x, B_k_cache, B_v_cache, B_wq, B_wo)
    return torch.concatenate([a, b], axis=-1)
```

```asm
; @launch grid=(256,1,1) block=(512,1,1) lds=163840
.amdgcn_target "amdgcn-amd-amdhsa--gfx950"
.text
.globl concat_heads__gqa_block_cached__gqa_block_cached__decode_kernel
.p2align 8
.type concat_heads__gqa_block_cached__gqa_block_cached__decode_kernel,@function
concat_heads__gqa_block_cached__gqa_block_cached__decode_kernel:
  s_cmp_ge_u32 s2, 256
  s_cbranch_scc1 L_end
  s_load_dwordx16 s[16:31], s[0:1], 0
  s_load_dwordx8 s[32:39], s[0:1], 64
  s_load_dwordx2 s[40:41], s[0:1], 96
  v_lshrrev_b32 v6, 6, v0
  v_and_b32 v1, 63, v0
  s_and_b32 s8, s2, 7
  v_readfirstlane_b32 s3, v6
  s_lshr_b32 s11, s2, 3
  s_lshr_b32 s4, s11, 2
  s_add_u32 s7, s11, s8
  s_and_b32 s7, s7, 3
  s_lshl_b32 s9, s8, 2
  s_add_u32 s9, s9, s7
  s_lshr_b32 s6, s9, 4
  s_lshl_b32 s10, s6, 1
  s_xor_b32 s5, s9, s10
  s_and_b32 s5, s5, 15
  s_and_b32 s100, s11, 31
  v_lshrrev_b32 v180, 4, v1
  v_and_b32 v181, 15, v1
  v_lshlrev_b32 v3, 4, v1
  v_and_b32 v7, 3, v1
  v_bfe_u32 v8, v1, 2, 2
  v_mov_b32 v182, 0
  v_mov_b32 v183, 1
  v_lshl_add_u32 v9, v180, 2, 0
  v_xor_b32 v9, v9, v1
  v_lshlrev_b32 v186, 4, v9
  v_lshl_add_u32 v9, v180, 2, 1
  v_xor_b32 v9, v9, v1
  v_lshlrev_b32 v187, 4, v9
  v_lshl_add_u32 v9, v180, 2, 2
  v_xor_b32 v9, v9, v1
  v_lshlrev_b32 v188, 4, v9
  v_lshl_add_u32 v9, v180, 2, 3
  v_xor_b32 v9, v9, v1
  v_lshlrev_b32 v189, 4, v9
  s_sub_u32 s79, s3, 4
  s_lshl_b32 s83, s7, 3
  s_add_u32 s83, s83, s4
  s_lshl_b32 s14, s83, 22
  s_bfe_u32 s10, s8, 0x20000
  s_lshl_b32 s10, s10, 15
  s_or_b32 s14, s14, s10
  s_bfe_u32 s10, s8, 0x10002
  s_lshl_b32 s10, s10, 21
  s_or_b32 s14, s14, s10
  s_bfe_u32 s10, s2, 0x10003
  s_lshl_b32 s10, s10, 13
  s_or_b32 s14, s14, s10
  s_bfe_u32 s10, s2, 0x10004
  s_lshl_b32 s10, s10, 12
  s_or_b32 s14, s14, s10
  s_mul_i32 s83, s83, 4352
  s_add_u32 s83, s83, 327680
  s_mov_b32 s46, 134217728
  s_mov_b32 s47, 0x20000
  s_mov_b32 s50, 134217728
  s_mov_b32 s51, 0x20000
  s_mov_b32 s54, 4194304
  s_mov_b32 s55, 0x20000
  s_mov_b32 s58, 4194304
  s_mov_b32 s59, 0x20000
  s_mov_b32 s62, 4096
  s_mov_b32 s63, 0x20000
  s_mov_b32 s66, 3145728
  s_mov_b32 s67, 0x20000
  s_mov_b32 s74, 8192
  s_mov_b32 s75, 0x20000
  s_mov_b32 s77, 0x05040100
  s_mov_b32 s78, 0x07060302
  s_mov_b32 s76, 0x3e0293ee
  s_mov_b32 s82, 0
  s_mov_b32 s80, 0
  s_cmp_eq_u32 s6, 0
  s_waitcnt lgkmcnt(0)
  s_cselect_b64 s[52:53], s[22:23], s[32:33]
  s_cselect_b64 s[60:61], s[16:17], s[26:27]
  s_mov_b64 s[44:45], s[18:19]
  s_mov_b64 s[48:49], s[30:31]
  s_cselect_b64 s[56:57], s[24:25], s[34:35]
  s_mov_b64 s[64:65], s[40:41]
  s_mov_b64 s[72:73], s[36:37]
  s_cmp_ge_u32 s3, 4
  s_cbranch_scc1 L_wwave
  s_cmp_eq_u32 s3, 3
  s_cbranch_scc1 L_helper
  s_cmp_lg_u32 s3, 0
  s_cbranch_scc1 L_cons
  s_setprio 1
  s_mov_b32 s36, s14
  s_mov_b32 s81, 0
  s_mov_b32 s42, 32768
  s_mov_b32 s15, 0
  s_mov_b32 s43, 0
  s_mov_b32 s37, 32
  s_mov_b32 s72, -1000
  s_mov_b32 s73, 0
  s_add_u32 m0, s42, 0
  s_xor_b32 s13, s14, 0
  buffer_load_dwordx4 v186, s[44:47], s13 offen offset:0 nt lds
  buffer_load_dwordx4 v187, s[44:47], s13 offen offset:1024 nt lds
  buffer_load_dwordx4 v188, s[44:47], s13 offen offset:2048 nt lds
  buffer_load_dwordx4 v189, s[44:47], s13 offen offset:3072 nt lds
  s_add_u32 m0, s42, 4096
  s_xor_b32 s13, s14, 8192
  buffer_load_dwordx4 v186, s[44:47], s13 offen offset:0 nt lds
  buffer_load_dwordx4 v187, s[44:47], s13 offen offset:1024 nt lds
  buffer_load_dwordx4 v188, s[44:47], s13 offen offset:2048 nt lds
  buffer_load_dwordx4 v189, s[44:47], s13 offen offset:3072 nt lds
  s_add_u32 m0, s42, 8192
  s_xor_b32 s13, s14, 4096
  buffer_load_dwordx4 v186, s[44:47], s13 offen offset:0 nt lds
  buffer_load_dwordx4 v187, s[44:47], s13 offen offset:1024 nt lds
  buffer_load_dwordx4 v188, s[44:47], s13 offen offset:2048 nt lds
  buffer_load_dwordx4 v189, s[44:47], s13 offen offset:3072 nt lds
  s_add_u32 m0, s42, 12288
  s_xor_b32 s13, s14, 12288
  buffer_load_dwordx4 v186, s[44:47], s13 offen offset:0 nt lds
  buffer_load_dwordx4 v187, s[44:47], s13 offen offset:1024 nt lds
  buffer_load_dwordx4 v188, s[44:47], s13 offen offset:2048 nt lds
  buffer_load_dwordx4 v189, s[44:47], s13 offen offset:3072 nt lds
  s_or_b32 s81, s81, 0xffe1bfff
  s_add_u32 s81, s81, 1
  s_and_b32 s81, s81, 0x1e4000
  s_xor_b32 s14, s36, s81
  s_add_u32 s42, s42, 16384
  s_cmp_ge_u32 s42, 163840
  s_cselect_b32 s42, 32768, s42
  s_xor_b32 s43, s43, 4
  s_add_u32 s15, s15, 1
  v_xor_b32 v190, v186, v3
  v_xor_b32 v191, v187, v3
  v_xor_b32 v192, v188, v3
  v_xor_b32 v193, v189, v3
  v_lshrrev_b32 v2, 3, v1
  v_bfe_u32 v9, v1, 4, 1
  v_xor_b32 v2, v2, v9
  v_lshlrev_b32 v2, 10, v2
  v_and_b32 v9, 7, v1
  v_lshl_add_u32 v196, v9, 4, v2
  v_xor_b32 v197, 32, v196
  v_xor_b32 v198, 64, v196
  v_xor_b32 v199, 96, v196
  s_lshl_b32 s39, s100, 17
  s_and_b32 s11, s8, 3
  s_lshl_b32 s11, s11, 8
  s_add_u32 s39, s39, s11
  s_andn2_b32 s38, s36, 0x3fffff
  s_barrier
L_lloop:
  s_cmp_lg_u32 s15, 6
  s_cbranch_scc1 L_nowq
L_wq:
  ds_read_b32 v11, v182 offset:48
  s_add_u32 s80, s80, 1
  s_waitcnt lgkmcnt(0)
  v_readfirstlane_b32 s10, v11
  s_cmp_ge_u32 s80, 16777216
  s_cbranch_scc1 L_wq_ok
  s_cmp_ge_i32 s10, 4
  s_cbranch_scc1 L_wq_ok
  s_waitcnt vmcnt(0)
  s_add_i32 s11, s15, 0
  v_mov_b32 v6, s11
  s_mov_b64 exec, 1
  ds_max_i32 v182, v6 offset:0
  s_mov_b64 exec, -1
  s_sleep 1
  s_branch L_wq
L_wq_ok:
L_nowq:
  s_cmp_lt_u32 s15, 8
  s_cbranch_scc1 L_isfree
  ds_read_b32 v10, v182 offset:56
  v_mov_b32 v184, s43
  s_sub_u32 s12, s15, 7
L_freea:
  ds_read_b32 v11, v184 offset:24
  s_add_u32 s80, s80, 1
  s_waitcnt lgkmcnt(0)
  v_readfirstlane_b32 s10, v11
  s_cmp_ge_u32 s80, 16777216
  s_cbranch_scc1 L_freea_ok
  s_cmp_ge_i32 s10, s12
  s_cbranch_scc1 L_freea_ok
  s_waitcnt vmcnt(0)
  s_add_i32 s11, s15, 0
  v_mov_b32 v6, s11
  s_mov_b64 exec, 1
  ds_max_i32 v182, v6 offset:0
  s_mov_b64 exec, -1
  s_sleep 1
  s_branch L_freea
L_freea_ok:
  v_readfirstlane_b32 s73, v10
L_isfree:
  s_cmp_le_u32 s73, 7
  s_cbranch_scc1 L_nf0
  s_waitcnt vmcnt(32)
  s_add_u32 m0, s42, 0
  s_xor_b32 s13, s14, 0
  buffer_load_dwordx4 v186, s[44:47], s13 offen offset:0 nt lds
  buffer_load_dwordx4 v187, s[44:47], s13 offen offset:1024 nt lds
  buffer_load_dwordx4 v188, s[44:47], s13 offen offset:2048 nt lds
  buffer_load_dwordx4 v189, s[44:47], s13 offen offset:3072 nt lds
  s_add_i32 s11, s15, -2
  v_mov_b32 v6, s11
  s_mov_b64 exec, 1
  ds_max_i32 v182, v6 offset:0
  s_mov_b64 exec, -1
  s_waitcnt vmcnt(32)
  s_add_u32 m0, s42, 4096
  s_xor_b32 s13, s14, 8192
  buffer_load_dwordx4 v186, s[44:47], s13 offen offset:0 nt lds
  buffer_load_dwordx4 v187, s[44:47], s13 offen offset:1024 nt lds
  buffer_load_dwordx4 v188, s[44:47], s13 offen offset:2048 nt lds
  buffer_load_dwordx4 v189, s[44:47], s13 offen offset:3072 nt lds
  s_waitcnt vmcnt(32)
  s_add_u32 m0, s42, 8192
  s_xor_b32 s13, s14, 4096
  buffer_load_dwordx4 v186, s[44:47], s13 offen offset:0 nt lds
  buffer_load_dwordx4 v187, s[44:47], s13 offen offset:1024 nt lds
  buffer_load_dwordx4 v188, s[44:47], s13 offen offset:2048 nt lds
  buffer_load_dwordx4 v189, s[44:47], s13 offen offset:3072 nt lds
  s_waitcnt vmcnt(32)
  s_add_u32 m0, s42, 12288
  s_xor_b32 s13, s14, 12288
  buffer_load_dwordx4 v186, s[44:47], s13 offen offset:0 nt lds
  buffer_load_dwordx4 v187, s[44:47], s13 offen offset:1024 nt lds
  buffer_load_dwordx4 v188, s[44:47], s13 offen offset:2048 nt lds
  buffer_load_dwordx4 v189, s[44:47], s13 offen offset:3072 nt lds
  s_or_b32 s81, s81, 0xffe1bfff
  s_add_u32 s81, s81, 1
  s_and_b32 s81, s81, 0x1e4000
  s_xor_b32 s14, s36, s81
  s_add_u32 s42, s42, 16384
  s_cmp_ge_u32 s42, 163840
  s_cselect_b32 s42, 32768, s42
  s_xor_b32 s43, s43, 4
  s_add_u32 s15, s15, 1
  s_branch L_tdone
L_nf0:
  s_cmp_le_u32 s73, 6
  s_cbranch_scc1 L_nf1
  s_waitcnt vmcnt(24)
  s_add_u32 m0, s42, 0
  s_xor_b32 s13, s14, 0
  buffer_load_dwordx4 v186, s[44:47], s13 offen offset:0 nt lds
  buffer_load_dwordx4 v187, s[44:47], s13 offen offset:1024 nt lds
  buffer_load_dwordx4 v188, s[44:47], s13 offen offset:2048 nt lds
  buffer_load_dwordx4 v189, s[44:47], s13 offen offset:3072 nt lds
  s_waitcnt vmcnt(24)
  s_add_u32 m0, s42, 4096
  s_xor_b32 s13, s14, 8192
  buffer_load_dwordx4 v186, s[44:47], s13 offen offset:0 nt lds
  buffer_load_dwordx4 v187, s[44:47], s13 offen offset:1024 nt lds
  buffer_load_dwordx4 v188, s[44:47], s13 offen offset:2048 nt lds
  buffer_load_dwordx4 v189, s[44:47], s13 offen offset:3072 nt lds
  s_waitcnt vmcnt(24)
  s_add_u32 m0, s42, 8192
  s_xor_b32 s13, s14, 4096
  buffer_load_dwordx4 v186, s[44:47], s13 offen offset:0 nt lds
  buffer_load_dwordx4 v187, s[44:47], s13 offen offset:1024 nt lds
  buffer_load_dwordx4 v188, s[44:47], s13 offen offset:2048 nt lds
  buffer_load_dwordx4 v189, s[44:47], s13 offen offset:3072 nt lds
  s_add_i32 s11, s15, -1
  v_mov_b32 v6, s11
  s_mov_b64 exec, 1
  ds_max_i32 v182, v6 offset:0
  s_mov_b64 exec, -1
  s_waitcnt vmcnt(24)
  s_add_u32 m0, s42, 12288
  s_xor_b32 s13, s14, 12288
  buffer_load_dwordx4 v186, s[44:47], s13 offen offset:0 nt lds
  buffer_load_dwordx4 v187, s[44:47], s13 offen offset:1024 nt lds
  buffer_load_dwordx4 v188, s[44:47], s13 offen offset:2048 nt lds
  buffer_load_dwordx4 v189, s[44:47], s13 offen offset:3072 nt lds
  s_or_b32 s81, s81, 0xffe1bfff
  s_add_u32 s81, s81, 1
  s_and_b32 s81, s81, 0x1e4000
  s_xor_b32 s14, s36, s81
  s_add_u32 s42, s42, 16384
  s_cmp_ge_u32 s42, 163840
  s_cselect_b32 s42, 32768, s42
  s_xor_b32 s43, s43, 4
  s_add_u32 s15, s15, 1
  s_branch L_tdone
L_nf1:
  s_cmp_le_u32 s73, 5
  s_cbranch_scc1 L_nf2
  s_waitcnt vmcnt(20)
  s_add_u32 m0, s42, 0
  s_xor_b32 s13, s14, 0
  buffer_load_dwordx4 v186, s[44:47], s13 offen offset:0 nt lds
  buffer_load_dwordx4 v187, s[44:47], s13 offen offset:1024 nt lds
  buffer_load_dwordx4 v188, s[44:47], s13 offen offset:2048 nt lds
  buffer_load_dwordx4 v189, s[44:47], s13 offen offset:3072 nt lds
  s_waitcnt vmcnt(20)
  s_add_u32 m0, s42, 4096
  s_xor_b32 s13, s14, 8192
  buffer_load_dwordx4 v186, s[44:47], s13 offen offset:0 nt lds
  buffer_load_dwordx4 v187, s[44:47], s13 offen offset:1024 nt lds
  buffer_load_dwordx4 v188, s[44:47], s13 offen offset:2048 nt lds
  buffer_load_dwordx4 v189, s[44:47], s13 offen offset:3072 nt lds
  s_add_i32 s11, s15, -1
  v_mov_b32 v6, s11
  s_mov_b64 exec, 1
  ds_max_i32 v182, v6 offset:0
  s_mov_b64 exec, -1
  s_waitcnt vmcnt(20)
  s_add_u32 m0, s42, 8192
  s_xor_b32 s13, s14, 4096
  buffer_load_dwordx4 v186, s[44:47], s13 offen offset:0 nt lds
  buffer_load_dwordx4 v187, s[44:47], s13 offen offset:1024 nt lds
  buffer_load_dwordx4 v188, s[44:47], s13 offen offset:2048 nt lds
  buffer_load_dwordx4 v189, s[44:47], s13 offen offset:3072 nt lds
  s_waitcnt vmcnt(20)
  s_add_u32 m0, s42, 12288
  s_xor_b32 s13, s14, 12288
  buffer_load_dwordx4 v186, s[44:47], s13 offen offset:0 nt lds
  buffer_load_dwordx4 v187, s[44:47], s13 offen offset:1024 nt lds
  buffer_load_dwordx4 v188, s[44:47], s13 offen offset:2048 nt lds
  buffer_load_dwordx4 v189, s[44:47], s13 offen offset:3072 nt lds
  s_or_b32 s81, s81, 0xffe1bfff
  s_add_u32 s81, s81, 1
  s_and_b32 s81, s81, 0x1e4000
  s_xor_b32 s14, s36, s81
  s_add_u32 s42, s42, 16384
  s_cmp_ge_u32 s42, 163840
  s_cselect_b32 s42, 32768, s42
  s_xor_b32 s43, s43, 4
  s_add_u32 s15, s15, 1
  s_branch L_tdone
L_nf2:
  s_waitcnt vmcnt(16)
  s_add_u32 m0, s42, 0
  s_xor_b32 s13, s14, 0
  buffer_load_dwordx4 v186, s[44:47], s13 offen offset:0 nt lds
  buffer_load_dwordx4 v187, s[44:47], s13 offen offset:1024 nt lds
  buffer_load_dwordx4 v188, s[44:47], s13 offen offset:2048 nt lds
  buffer_load_dwordx4 v189, s[44:47], s13 offen offset:3072 nt lds
  s_add_i32 s11, s15, -1
  v_mov_b32 v6, s11
  s_mov_b64 exec, 1
  ds_max_i32 v182, v6 offset:0
  s_mov_b64 exec, -1
  s_waitcnt vmcnt(16)
  s_add_u32 m0, s42, 4096
  s_xor_b32 s13, s14, 8192
  buffer_load_dwordx4 v186, s[44:47], s13 offen offset:0 nt lds
  buffer_load_dwordx4 v187, s[44:47], s13 offen offset:1024 nt lds
  buffer_load_dwordx4 v188, s[44:47], s13 offen offset:2048 nt lds
  buffer_load_dwordx4 v189, s[44:47], s13 offen offset:3072 nt lds
  s_waitcnt vmcnt(16)
  s_add_u32 m0, s42, 8192
  s_xor_b32 s13, s14, 4096
  buffer_load_dwordx4 v186, s[44:47], s13 offen offset:0 nt lds
  buffer_load_dwordx4 v187, s[44:47], s13 offen offset:1024 nt lds
  buffer_load_dwordx4 v188, s[44:47], s13 offen offset:2048 nt lds
  buffer_load_dwordx4 v189, s[44:47], s13 offen offset:3072 nt lds
  s_waitcnt vmcnt(16)
  s_add_u32 m0, s42, 12288
  s_xor_b32 s13, s14, 12288
  buffer_load_dwordx4 v186, s[44:47], s13 offen offset:0 nt lds
  buffer_load_dwordx4 v187, s[44:47], s13 offen offset:1024 nt lds
  buffer_load_dwordx4 v188, s[44:47], s13 offen offset:2048 nt lds
  buffer_load_dwordx4 v189, s[44:47], s13 offen offset:3072 nt lds
  s_or_b32 s81, s81, 0xffe1bfff
  s_add_u32 s81, s81, 1
  s_and_b32 s81, s81, 0x1e4000
  s_xor_b32 s14, s36, s81
  s_add_u32 s42, s42, 16384
  s_cmp_ge_u32 s42, 163840
  s_cselect_b32 s42, 32768, s42
  s_xor_b32 s43, s43, 4
  s_add_u32 s15, s15, 1
L_tdone:
  s_cmp_lt_u32 s15, s37
  s_cbranch_scc1 L_lloop
  s_add_u32 s82, s82, 1
  s_cmp_eq_u32 s82, 4
  s_cbranch_scc1 L_lstat
  s_mov_b64 s[44:45], s[20:21]
  s_mov_b64 s[20:21], s[28:29]
  s_cmp_eq_u32 s82, 2
  s_cselect_b64 s[20:21], s[30:31], s[20:21]
  v_xor_b32 v186, v186, v190
  v_xor_b32 v187, v187, v191
  v_xor_b32 v188, v188, v192
  v_xor_b32 v189, v189, v193
  s_mov_b32 s14, s36
  s_mov_b32 s81, 0
  s_cmp_eq_u32 s82, 1
  s_cselect_b32 s10, 32, 30
  s_add_u32 s37, s37, s10
  s_cmp_eq_u32 s82, 3
  s_cselect_b32 s10, 2, 0
  s_sub_u32 s37, s37, s10
  s_branch L_lloop
L_lstat:
  v_mov_b32 v184, s43
  s_sub_u32 s12, s15, 7
L_freeb0:
  ds_read_b32 v11, v184 offset:24
  s_add_u32 s80, s80, 1
  s_waitcnt lgkmcnt(0)
  v_readfirstlane_b32 s10, v11
  s_cmp_ge_u32 s80, 16777216
  s_cbranch_scc1 L_freeb0_ok
  s_cmp_ge_i32 s10, s12
  s_cbranch_scc1 L_freeb0_ok
  s_waitcnt vmcnt(0)
  s_add_i32 s11, s15, 0
  v_mov_b32 v6, s11
  s_mov_b64 exec, 1
  ds_max_i32 v182, v6 offset:0
  s_mov_b64 exec, -1
  s_sleep 1
  s_branch L_freeb0
L_freeb0_ok:
  s_waitcnt vmcnt(16)
  s_add_u32 m0, s42, 0
  s_xor_b32 s13, s14, 0
  buffer_load_dwordx4 v186, s[44:47], s13 offen offset:0 nt lds
  buffer_load_dwordx4 v187, s[44:47], s13 offen offset:1024 nt lds
  buffer_load_dwordx4 v188, s[44:47], s13 offen offset:2048 nt lds
  buffer_load_dwordx4 v189, s[44:47], s13 offen offset:3072 nt lds
  s_add_i32 s11, s15, -1
  v_mov_b32 v6, s11
  s_mov_b64 exec, 1
  ds_max_i32 v182, v6 offset:0
  s_mov_b64 exec, -1
  s_waitcnt vmcnt(16)
  s_add_u32 m0, s42, 4096
  s_xor_b32 s13, s14, 8192
  buffer_load_dwordx4 v186, s[44:47], s13 offen offset:0 nt lds
  buffer_load_dwordx4 v187, s[44:47], s13 offen offset:1024 nt lds
  buffer_load_dwordx4 v188, s[44:47], s13 offen offset:2048 nt lds
  buffer_load_dwordx4 v189, s[44:47], s13 offen offset:3072 nt lds
  s_waitcnt vmcnt(16)
  s_add_u32 m0, s42, 8192
  s_xor_b32 s13, s14, 4096
  buffer_load_dwordx4 v186, s[44:47], s13 offen offset:0 nt lds
  buffer_load_dwordx4 v187, s[44:47], s13 offen offset:1024 nt lds
  buffer_load_dwordx4 v188, s[44:47], s13 offen offset:2048 nt lds
  buffer_load_dwordx4 v189, s[44:47], s13 offen offset:3072 nt lds
  s_waitcnt vmcnt(16)
  v_mov_b32 v20, 1
  s_mov_b64 exec, 1
  buffer_atomic_add v20, v182, s[64:67], s83 offen sc0 sc1
  s_mov_b64 exec, -1
  s_add_u32 m0, s42, 12288
  s_xor_b32 s13, s14, 12288
  buffer_load_dwordx4 v186, s[44:47], s13 offen offset:0 nt lds
  buffer_load_dwordx4 v187, s[44:47], s13 offen offset:1024 nt lds
  buffer_load_dwordx4 v188, s[44:47], s13 offen offset:2048 nt lds
  buffer_load_dwordx4 v189, s[44:47], s13 offen offset:3072 nt lds
  s_or_b32 s81, s81, 0xffe1bfff
  s_add_u32 s81, s81, 1
  s_and_b32 s81, s81, 0x1e4000
  s_xor_b32 s14, s36, s81
  s_add_u32 s42, s42, 16384
  s_cmp_ge_u32 s42, 163840
  s_cselect_b32 s42, 32768, s42
  s_xor_b32 s43, s43, 4
  s_add_u32 s15, s15, 1
  v_mov_b32 v184, s43
  s_sub_u32 s12, s15, 7
L_freeb1:
  ds_read_b32 v11, v184 offset:24
  s_add_u32 s80, s80, 1
  s_waitcnt lgkmcnt(0)
  v_readfirstlane_b32 s10, v11
  s_cmp_ge_u32 s80, 16777216
  s_cbranch_scc1 L_freeb1_ok
  s_cmp_ge_i32 s10, s12
  s_cbranch_scc1 L_freeb1_ok
  s_waitcnt vmcnt(0)
  s_add_i32 s11, s15, 0
  v_mov_b32 v6, s11
  s_mov_b64 exec, 1
  ds_max_i32 v182, v6 offset:0
  s_mov_b64 exec, -1
  s_sleep 1
  s_branch L_freeb1
L_freeb1_ok:
  s_waitcnt vmcnt(16)
  s_add_u32 m0, s42, 0
  s_xor_b32 s13, s14, 0
  buffer_load_dwordx4 v186, s[44:47], s13 offen offset:0 nt lds
  buffer_load_dwordx4 v187, s[44:47], s13 offen offset:1024 nt lds
  buffer_load_dwordx4 v188, s[44:47], s13 offen offset:2048 nt lds
  buffer_load_dwordx4 v189, s[44:47], s13 offen offset:3072 nt lds
  s_add_i32 s11, s15, -1
  v_mov_b32 v6, s11
  s_mov_b64 exec, 1
  ds_max_i32 v182, v6 offset:0
  s_mov_b64 exec, -1
  s_waitcnt vmcnt(16)
  s_add_u32 m0, s42, 4096
  s_xor_b32 s13, s14, 8192
  buffer_load_dwordx4 v186, s[44:47], s13 offen offset:0 nt lds
  buffer_load_dwordx4 v187, s[44:47], s13 offen offset:1024 nt lds
  buffer_load_dwordx4 v188, s[44:47], s13 offen offset:2048 nt lds
  buffer_load_dwordx4 v189, s[44:47], s13 offen offset:3072 nt lds
  s_waitcnt vmcnt(16)
  s_add_u32 m0, s42, 8192
  s_xor_b32 s13, s14, 4096
  buffer_load_dwordx4 v186, s[44:47], s13 offen offset:0 nt lds
  buffer_load_dwordx4 v187, s[44:47], s13 offen offset:1024 nt lds
  buffer_load_dwordx4 v188, s[44:47], s13 offen offset:2048 nt lds
  buffer_load_dwordx4 v189, s[44:47], s13 offen offset:3072 nt lds
  s_waitcnt vmcnt(16)
  v_mov_b32 v21, 1
  s_mov_b64 exec, 1
  buffer_atomic_add v21, v182, s[64:67], s83 offen sc0 sc1
  s_mov_b64 exec, -1
  s_add_u32 m0, s42, 12288
  s_xor_b32 s13, s14, 12288
  buffer_load_dwordx4 v186, s[44:47], s13 offen offset:0 nt lds
  buffer_load_dwordx4 v187, s[44:47], s13 offen offset:1024 nt lds
  buffer_load_dwordx4 v188, s[44:47], s13 offen offset:2048 nt lds
  buffer_load_dwordx4 v189, s[44:47], s13 offen offset:3072 nt lds
  s_or_b32 s81, s81, 0xffe1bfff
  s_add_u32 s81, s81, 1
  s_and_b32 s81, s81, 0x1e4000
  s_xor_b32 s14, s36, s81
  s_add_u32 s42, s42, 16384
  s_cmp_ge_u32 s42, 163840
  s_cselect_b32 s42, 32768, s42
  s_xor_b32 s43, s43, 4
  s_add_u32 s15, s15, 1
  s_mov_b64 s[44:45], s[28:29]
  v_xor_b32 v186, v186, v190
  v_xor_b32 v187, v187, v191
  v_xor_b32 v188, v188, v192
  v_xor_b32 v189, v189, v193
L_dloop:
  v_mov_b32 v184, s43
  s_sub_u32 s12, s15, 7
L_freec0:
  ds_read_b32 v11, v184 offset:24
  s_add_u32 s80, s80, 1
  s_waitcnt lgkmcnt(0)
  v_readfirstlane_b32 s10, v11
  s_cmp_ge_u32 s80, 16777216
  s_cbranch_scc1 L_freec0_ok
  s_cmp_ge_i32 s10, s12
  s_cbranch_scc1 L_freec0_ok
  s_waitcnt vmcnt(0)
  s_add_i32 s11, s15, 0
  v_mov_b32 v6, s11
  s_mov_b64 exec, 1
  ds_max_i32 v182, v6 offset:0
  s_mov_b64 exec, -1
  s_sleep 1
  s_branch L_freec0
L_freec0_ok:
  s_waitcnt vmcnt(21)
  v_readfirstlane_b32 s14, v20
  s_cmp_ge_u32 s15, 156
  s_cbranch_scc1 L_lend
  s_cmp_ge_u32 s14, 32
  s_cbranch_scc1 L_lend
  s_add_u32 s11, s14, 480
  s_mov_b32 s14, s38
  s_bfe_u32 s10, s11, 0x20000
  s_lshl_b32 s10, s10, 15
  s_or_b32 s14, s14, s10
  s_bfe_u32 s10, s11, 0x10002
  s_lshl_b32 s10, s10, 21
  s_or_b32 s14, s14, s10
  s_bfe_u32 s10, s11, 0x10003
  s_lshl_b32 s10, s10, 12
  s_or_b32 s14, s14, s10
  s_bfe_u32 s10, s11, 0x10004
  s_lshl_b32 s10, s10, 14
  s_or_b32 s14, s14, s10
  s_bfe_u32 s10, s11, 0x40005
  s_lshl_b32 s10, s10, 17
  s_or_b32 s14, s14, s10
  s_waitcnt vmcnt(20)
  s_add_u32 m0, s42, 0
  s_xor_b32 s13, s14, 0
  buffer_load_dwordx4 v186, s[44:47], s13 offen offset:0 nt lds
  buffer_load_dwordx4 v187, s[44:47], s13 offen offset:1024 nt lds
  buffer_load_dwordx4 v188, s[44:47], s13 offen offset:2048 nt lds
  buffer_load_dwordx4 v189, s[44:47], s13 offen offset:3072 nt lds
  s_waitcnt vmcnt(20)
  s_add_u32 m0, s42, 4096
  s_xor_b32 s13, s14, 8192
  buffer_load_dwordx4 v186, s[44:47], s13 offen offset:0 nt lds
  buffer_load_dwordx4 v187, s[44:47], s13 offen offset:1024 nt lds
  buffer_load_dwordx4 v188, s[44:47], s13 offen offset:2048 nt lds
  buffer_load_dwordx4 v189, s[44:47], s13 offen offset:3072 nt lds
  s_add_i32 s11, s15, -1
  v_mov_b32 v6, s11
  s_mov_b64 exec, 1
  ds_max_i32 v182, v6 offset:0
  s_mov_b64 exec, -1
  s_waitcnt vmcnt(20)
  s_add_u32 m0, s42, 8192
  s_xor_b32 s13, s14, 0
  buffer_load_dwordx4 v3, s[48:51], s13 offen offset:0 nt lds
  buffer_load_dwordx4 v3, s[48:51], s13 offen offset:1024 nt lds
  buffer_load_dwordx4 v3, s[48:51], s13 offen offset:2048 nt lds
  buffer_load_dwordx4 v3, s[48:51], s13 offen offset:3072 nt lds
  s_waitcnt vmcnt(20)
  v_mov_b32 v20, 1
  s_mov_b64 exec, 1
  buffer_atomic_add v20, v182, s[64:67], s83 offen sc0 sc1
  s_mov_b64 exec, -1
  s_add_u32 m0, s42, 12288
  s_xor_b32 s13, s14, 8192
  buffer_load_dwordx4 v3, s[48:51], s13 offen offset:0 nt lds
  buffer_load_dwordx4 v3, s[48:51], s13 offen offset:1024 nt lds
  buffer_load_dwordx4 v3, s[48:51], s13 offen offset:2048 nt lds
  buffer_load_dwordx4 v3, s[48:51], s13 offen offset:3072 nt lds
  s_add_u32 s42, s42, 16384
  s_cmp_ge_u32 s42, 163840
  s_cselect_b32 s42, 32768, s42
  s_xor_b32 s43, s43, 4
  s_add_u32 s15, s15, 1
  v_mov_b32 v184, s43
  s_sub_u32 s12, s15, 7
L_freec1:
  ds_read_b32 v11, v184 offset:24
  s_add_u32 s80, s80, 1
  s_waitcnt lgkmcnt(0)
  v_readfirstlane_b32 s10, v11
  s_cmp_ge_u32 s80, 16777216
  s_cbranch_scc1 L_freec1_ok
  s_cmp_ge_i32 s10, s12
  s_cbranch_scc1 L_freec1_ok
  s_waitcnt vmcnt(0)
  s_add_i32 s11, s15, 0
  v_mov_b32 v6, s11
  s_mov_b64 exec, 1
  ds_max_i32 v182, v6 offset:0
  s_mov_b64 exec, -1
  s_sleep 1
  s_branch L_freec1
L_freec1_ok:
  s_waitcnt vmcnt(21)
  v_readfirstlane_b32 s14, v21
  s_cmp_ge_u32 s15, 156
  s_cbranch_scc1 L_lend
  s_cmp_ge_u32 s14, 32
  s_cbranch_scc1 L_lend
  s_add_u32 s11, s14, 480
  s_mov_b32 s14, s38
  s_bfe_u32 s10, s11, 0x20000
  s_lshl_b32 s10, s10, 15
  s_or_b32 s14, s14, s10
  s_bfe_u32 s10, s11, 0x10002
  s_lshl_b32 s10, s10, 21
  s_or_b32 s14, s14, s10
  s_bfe_u32 s10, s11, 0x10003
  s_lshl_b32 s10, s10, 12
  s_or_b32 s14, s14, s10
  s_bfe_u32 s10, s11, 0x10004
  s_lshl_b32 s10, s10, 14
  s_or_b32 s14, s14, s10
  s_bfe_u32 s10, s11, 0x40005
  s_lshl_b32 s10, s10, 17
  s_or_b32 s14, s14, s10
  s_waitcnt vmcnt(20)
  s_add_u32 m0, s42, 0
  s_xor_b32 s13, s14, 0
  buffer_load_dwordx4 v186, s[44:47], s13 offen offset:0 nt lds
  buffer_load_dwordx4 v187, s[44:47], s13 offen offset:1024 nt lds
  buffer_load_dwordx4 v188, s[44:47], s13 offen offset:2048 nt lds
  buffer_load_dwordx4 v189, s[44:47], s13 offen offset:3072 nt lds
  s_waitcnt vmcnt(20)
  s_add_u32 m0, s42, 4096
  s_xor_b32 s13, s14, 8192
  buffer_load_dwordx4 v186, s[44:47], s13 offen offset:0 nt lds
  buffer_load_dwordx4 v187, s[44:47], s13 offen offset:1024 nt lds
  buffer_load_dwordx4 v188, s[44:47], s13 offen offset:2048 nt lds
  buffer_load_dwordx4 v189, s[44:47], s13 offen offset:3072 nt lds
  s_add_i32 s11, s15, -1
  v_mov_b32 v6, s11
  s_mov_b64 exec, 1
  ds_max_i32 v182, v6 offset:0
  s_mov_b64 exec, -1
  s_waitcnt vmcnt(20)
  s_add_u32 m0, s42, 8192
  s_xor_b32 s13, s14, 0
  buffer_load_dwordx4 v3, s[48:51], s13 offen offset:0 nt lds
  buffer_load_dwordx4 v3, s[48:51], s13 offen offset:1024 nt lds
  buffer_load_dwordx4 v3, s[48:51], s13 offen offset:2048 nt lds
  buffer_load_dwordx4 v3, s[48:51], s13 offen offset:3072 nt lds
  s_waitcnt vmcnt(20)
  v_mov_b32 v21, 1
  s_mov_b64 exec, 1
  buffer_atomic_add v21, v182, s[64:67], s83 offen sc0 sc1
  s_mov_b64 exec, -1
  s_add_u32 m0, s42, 12288
  s_xor_b32 s13, s14, 8192
  buffer_load_dwordx4 v3, s[48:51], s13 offen offset:0 nt lds
  buffer_load_dwordx4 v3, s[48:51], s13 offen offset:1024 nt lds
  buffer_load_dwordx4 v3, s[48:51], s13 offen offset:2048 nt lds
  buffer_load_dwordx4 v3, s[48:51], s13 offen offset:3072 nt lds
  s_add_u32 s42, s42, 16384
  s_cmp_ge_u32 s42, 163840
  s_cselect_b32 s42, 32768, s42
  s_xor_b32 s43, s43, 4
  s_add_u32 s15, s15, 1
  s_branch L_dloop
L_lend:
  v_mov_b32 v7, s15
  ds_write_b32 v182, v7 offset:4
  s_waitcnt vmcnt(16)
  s_add_i32 s11, s15, -1
  v_mov_b32 v6, s11
  s_mov_b64 exec, 1
  ds_max_i32 v182, v6 offset:0
  s_mov_b64 exec, -1
L_lend2:
  s_add_u32 m0, s42, 0
  s_add_u32 s10, s39, 0
  buffer_load_dwordx4 v196, s[56:59], s10 offen nt lds
  s_add_u32 m0, s42, 1024
  s_add_u32 s10, s39, 8192
  buffer_load_dwordx4 v197, s[56:59], s10 offen nt lds
  s_add_u32 m0, s42, 2048
  s_add_u32 s10, s39, 16384
  buffer_load_dwordx4 v198, s[56:59], s10 offen nt lds
  s_add_u32 m0, s42, 3072
  s_add_u32 s10, s39, 24576
  buffer_load_dwordx4 v199, s[56:59], s10 offen nt lds
  s_add_u32 m0, s42, 4096
  s_add_u32 s10, s39, 32768
  buffer_load_dwordx4 v196, s[56:59], s10 offen nt lds
  s_add_u32 m0, s42, 5120
  s_add_u32 s10, s39, 40960
  buffer_load_dwordx4 v197, s[56:59], s10 offen nt lds
  s_add_u32 m0, s42, 6144
  s_add_u32 s10, s39, 49152
  buffer_load_dwordx4 v198, s[56:59], s10 offen nt lds
  s_add_u32 m0, s42, 7168
  s_add_u32 s10, s39, 57344
  buffer_load_dwordx4 v199, s[56:59], s10 offen nt lds
  s_add_u32 s14, s42, 16384
  s_cmp_ge_u32 s14, 163840
  s_cselect_b32 s14, 32768, s14
  s_xor_b32 s43, s43, 4
  v_mov_b32 v184, s43
  s_sub_u32 s12, s15, 6
L_freex:
  ds_read_b32 v11, v184 offset:24
  s_add_u32 s80, s80, 1
  s_waitcnt lgkmcnt(0)
  v_readfirstlane_b32 s10, v11
  s_cmp_ge_u32 s80, 16777216
  s_cbranch_scc1 L_freex_ok
  s_cmp_ge_i32 s10, s12
  s_cbranch_scc1 L_freex_ok
  s_branch L_freex
L_freex_ok:
  s_waitcnt vmcnt(16)
  ds_write_b32 v182, v7 offset:8
  s_add_i32 s11, s15, -1
  v_mov_b32 v6, s11
  s_mov_b64 exec, 1
  ds_max_i32 v182, v6 offset:0
  s_mov_b64 exec, -1
  s_add_u32 m0, s42, 8192
  s_add_u32 s10, s39, 65536
  buffer_load_dwordx4 v196, s[56:59], s10 offen nt lds
  s_add_u32 m0, s42, 9216
  s_add_u32 s10, s39, 73728
  buffer_load_dwordx4 v197, s[56:59], s10 offen nt lds
  s_add_u32 m0, s42, 10240
  s_add_u32 s10, s39, 81920
  buffer_load_dwordx4 v198, s[56:59], s10 offen nt lds
  s_add_u32 m0, s42, 11264
  s_add_u32 s10, s39, 90112
  buffer_load_dwordx4 v199, s[56:59], s10 offen nt lds
  s_add_u32 m0, s42, 12288
  s_add_u32 s10, s39, 98304
  buffer_load_dwordx4 v196, s[56:59], s10 offen nt lds
  s_add_u32 m0, s42, 13312
  s_add_u32 s10, s39, 106496
  buffer_load_dwordx4 v197, s[56:59], s10 offen nt lds
  s_add_u32 m0, s42, 14336
  s_add_u32 s10, s39, 114688
  buffer_load_dwordx4 v198, s[56:59], s10 offen nt lds
  s_add_u32 m0, s42, 15360
  s_add_u32 s10, s39, 122880
  buffer_load_dwordx4 v199, s[56:59], s10 offen nt lds
  s_waitcnt vmcnt(16)
  s_add_i32 s11, s15, 0
  v_mov_b32 v6, s11
  s_mov_b64 exec, 1
  ds_max_i32 v182, v6 offset:0
  s_mov_b64 exec, -1
L_st6:
  v_mov_b32 v7, s42
  v_mov_b32 v8, s14
  s_add_u32 m0, s14, 0
  s_add_u32 s10, s39, 128
  buffer_load_dwordx4 v196, s[56:59], s10 offen nt lds
  s_add_u32 m0, s14, 1024
  s_add_u32 s10, s39, 8320
  buffer_load_dwordx4 v197, s[56:59], s10 offen nt lds
  s_add_u32 m0, s14, 2048
  s_add_u32 s10, s39, 16512
  buffer_load_dwordx4 v198, s[56:59], s10 offen nt lds
  s_add_u32 m0, s14, 3072
  s_add_u32 s10, s39, 24704
  buffer_load_dwordx4 v199, s[56:59], s10 offen nt lds
  s_add_u32 m0, s14, 4096
  s_add_u32 s10, s39, 32896
  buffer_load_dwordx4 v196, s[56:59], s10 offen nt lds
  s_add_u32 m0, s14, 5120
  s_add_u32 s10, s39, 41088
  buffer_load_dwordx4 v197, s[56:59], s10 offen nt lds
  s_add_u32 m0, s14, 6144
  s_add_u32 s10, s39, 49280
  buffer_load_dwordx4 v198, s[56:59], s10 offen nt lds
  s_add_u32 m0, s14, 7168
  s_add_u32 s10, s39, 57472
  buffer_load_dwordx4 v199, s[56:59], s10 offen nt lds
  s_add_u32 m0, s14, 8192
  s_add_u32 s10, s39, 65664
  buffer_load_dwordx4 v196, s[56:59], s10 offen nt lds
  s_add_u32 m0, s14, 9216
  s_add_u32 s10, s39, 73856
  buffer_load_dwordx4 v197, s[56:59], s10 offen nt lds
  s_add_u32 m0, s14, 10240
  s_add_u32 s10, s39, 82048
  buffer_load_dwordx4 v198, s[56:59], s10 offen nt lds
  s_add_u32 m0, s14, 11264
  s_add_u32 s10, s39, 90240
  buffer_load_dwordx4 v199, s[56:59], s10 offen nt lds
  s_add_u32 m0, s14, 12288
  s_add_u32 s10, s39, 98432
  buffer_load_dwordx4 v196, s[56:59], s10 offen nt lds
  s_add_u32 m0, s14, 13312
  s_add_u32 s10, s39, 106624
  buffer_load_dwordx4 v197, s[56:59], s10 offen nt lds
  s_add_u32 m0, s14, 14336
  s_add_u32 s10, s39, 114816
  buffer_load_dwordx4 v198, s[56:59], s10 offen nt lds
  s_add_u32 m0, s14, 15360
  s_add_u32 s10, s39, 123008
  buffer_load_dwordx4 v199, s[56:59], s10 offen nt lds
  s_waitcnt vmcnt(16)
  ds_write_b32 v182, v7 offset:16
  s_waitcnt vmcnt(0)
  ds_write_b32 v182, v8 offset:44
  s_endpgm
L_wwave:
  s_setprio 2
  v_lshrrev_b32 v6, 2, v1
  v_lshlrev_b32 v9, 4, v7
  v_lshl_add_u32 v10, v6, 13, v9
  s_lshl_b32 s10, s79, 20
  s_lshl_b32 s11, s4, 10
  s_add_u32 s10, s10, s11
  s_lshl_b32 s11, s5, 6
  s_add_u32 s10, s10, s11
  s_lshl_b32 s42, s79, 13
  s_add_u32 s42, s42, 131072
  s_add_u32 m0, s42, 0
  s_nop 0
  buffer_load_dwordx4 v10, s[52:55], s10 offen nt lds
  s_add_u32 m0, s42, 1024
  s_add_u32 s10, s10, 131072
  buffer_load_dwordx4 v10, s[52:55], s10 offen nt lds
  s_add_u32 m0, s42, 2048
  s_add_u32 s10, s10, 131072
  buffer_load_dwordx4 v10, s[52:55], s10 offen nt lds
  s_add_u32 m0, s42, 3072
  s_add_u32 s10, s10, 131072
  buffer_load_dwordx4 v10, s[52:55], s10 offen nt lds
  s_add_u32 m0, s42, 4096
  s_add_u32 s10, s10, 131072
  buffer_load_dwordx4 v10, s[52:55], s10 offen nt lds
  s_add_u32 m0, s42, 5120
  s_add_u32 s10, s10, 131072
  buffer_load_dwordx4 v10, s[52:55], s10 offen nt lds
  s_add_u32 m0, s42, 6144
  s_add_u32 s10, s10, 131072
  buffer_load_dwordx4 v10, s[52:55], s10 offen nt lds
  s_add_u32 m0, s42, 7168
  s_add_u32 s10, s10, 131072
  buffer_load_dwordx4 v10, s[52:55], s10 offen nt lds
  v_lshlrev_b32 v6, 10, v7
  v_lshl_add_u32 v6, v8, 6, v6
  v_lshl_add_u32 v6, v180, 4, v6
  s_lshl_b32 s11, s79, 8
  buffer_load_dwordx4 v[36:39], v6, s[60:63], s11 offen
  s_load_dword s81, s[40:41], 0x40000
  s_barrier
  v_lshlrev_b32 v9, 2, v181
  v_add_u32 v9, s42, v9
  v_lshl_add_u32 v6, v180, 9, v9
  v_lshl_add_u32 v10, v180, 2, v181
  v_lshlrev_b32 v10, 5, v10
  s_lshl_b32 s10, s79, 9
  v_add_u32 v10, s10, v10
  s_waitcnt vmcnt(0)
  ds_read_b32 v116, v6 offset:0
  ds_read_b32 v117, v6 offset:64
  ds_read_b32 v118, v6 offset:128
  ds_read_b32 v119, v6 offset:192
  ds_read_b32 v120, v6 offset:256
  ds_read_b32 v121, v6 offset:320
  ds_read_b32 v122, v6 offset:384
  ds_read_b32 v123, v6 offset:448
  ds_read_b32 v124, v6 offset:2048
  ds_read_b32 v125, v6 offset:2112
  ds_read_b32 v126, v6 offset:2176
  ds_read_b32 v127, v6 offset:2240
  ds_read_b32 v128, v6 offset:2304
  ds_read_b32 v129, v6 offset:2368
  ds_read_b32 v130, v6 offset:2432
  ds_read_b32 v131, v6 offset:2496
  ds_read_b32 v132, v6 offset:4096
  ds_read_b32 v133, v6 offset:4160
  ds_read_b32 v134, v6 offset:4224
  ds_read_b32 v135, v6 offset:4288
  ds_read_b32 v136, v6 offset:4352
  ds_read_b32 v137, v6 offset:4416
  ds_read_b32 v138, v6 offset:4480
  ds_read_b32 v139, v6 offset:4544
  ds_read_b32 v140, v6 offset:6144
  ds_read_b32 v141, v6 offset:6208
  ds_read_b32 v142, v6 offset:6272
  ds_read_b32 v143, v6 offset:6336
  ds_read_b32 v144, v6 offset:6400
  ds_read_b32 v145, v6 offset:6464
  ds_read_b32 v146, v6 offset:6528
  ds_read_b32 v147, v6 offset:6592
  v_mov_b32_dpp v40, v36 row_ror:12 row_mask:0xf bank_mask:0xf
  v_mov_b32_dpp v41, v37 row_ror:12 row_mask:0xf bank_mask:0xf
  v_mov_b32_dpp v42, v38 row_ror:12 row_mask:0xf bank_mask:0xf
  v_mov_b32_dpp v43, v39 row_ror:12 row_mask:0xf bank_mask:0xf
  v_mov_b32_dpp v44, v36 row_ror:8 row_mask:0xf bank_mask:0xf
  v_mov_b32_dpp v45, v37 row_ror:8 row_mask:0xf bank_mask:0xf
  v_mov_b32_dpp v46, v38 row_ror:8 row_mask:0xf bank_mask:0xf
  v_mov_b32_dpp v47, v39 row_ror:8 row_mask:0xf bank_mask:0xf
  v_mov_b32_dpp v48, v36 row_ror:4 row_mask:0xf bank_mask:0xf
  v_mov_b32_dpp v49, v37 row_ror:4 row_mask:0xf bank_mask:0xf
  v_mov_b32_dpp v50, v38 row_ror:4 row_mask:0xf bank_mask:0xf
  v_mov_b32_dpp v51, v39 row_ror:4 row_mask:0xf bank_mask:0xf
  s_waitcnt lgkmcnt(0)
  v_perm_b32 v148, v117, v116, s77
  v_perm_b32 v152, v117, v116, s78
  v_perm_b32 v149, v119, v118, s77
  v_perm_b32 v153, v119, v118, s78
  v_perm_b32 v150, v121, v120, s77
  v_perm_b32 v154, v121, v120, s78
  v_perm_b32 v151, v123, v122, s77
  v_perm_b32 v155, v123, v122, s78
  v_perm_b32 v156, v125, v124, s77
  v_perm_b32 v160, v125, v124, s78
  v_perm_b32 v157, v127, v126, s77
  v_perm_b32 v161, v127, v126, s78
  v_perm_b32 v158, v129, v128, s77
  v_perm_b32 v162, v129, v128, s78
  v_perm_b32 v159, v131, v130, s77
  v_perm_b32 v163, v131, v130, s78
  v_perm_b32 v164, v133, v132, s77
  v_perm_b32 v168, v133, v132, s78
  v_perm_b32 v165, v135, v134, s77
  v_perm_b32 v169, v135, v134, s78
  v_perm_b32 v166, v137, v136, s77
  v_perm_b32 v170, v137, v136, s78
  v_perm_b32 v167, v139, v138, s77
  v_perm_b32 v171, v139, v138, s78
  v_perm_b32 v172, v141, v140, s77
  v_perm_b32 v176, v141, v140, s78
  v_perm_b32 v173, v143, v142, s77
  v_perm_b32 v177, v143, v142, s78
  v_perm_b32 v174, v145, v144, s77
  v_perm_b32 v178, v145, v144, s78
  v_perm_b32 v175, v147, v146, s77
  v_perm_b32 v179, v147, v146, s78
  s_nop 1
  v_mfma_f32_16x16x32_bf16 v[20:23], v[148:151], v[36:39], 0
  v_mfma_f32_16x16x32_bf16 v[24:27], v[152:155], v[36:39], 0
  v_mfma_f32_16x16x32_bf16 v[20:23], v[156:159], v[40:43], v[20:23]
  v_mfma_f32_16x16x32_bf16 v[24:27], v[160:163], v[40:43], v[24:27]
  v_mfma_f32_16x16x32_bf16 v[20:23], v[164:167], v[44:47], v[20:23]
  v_mfma_f32_16x16x32_bf16 v[24:27], v[168:171], v[44:47], v[24:27]
  v_mfma_f32_16x16x32_bf16 v[20:23], v[172:175], v[48:51], v[20:23]
  v_mfma_f32_16x16x32_bf16 v[24:27], v[176:179], v[48:51], v[24:27]
  s_mov_b32 exec_lo, 0x000f000f
  s_mov_b32 exec_hi, 0x000f000f
  s_nop 7
  ds_write_b128 v10, v[20:23] offset:7040
  ds_write_b128 v10, v[24:27] offset:7056
  s_mov_b64 exec, 1
  ds_add_u32 v182, v183 offset:48
  s_mov_b64 exec, -1
  v_mul_u32_u24 v193, 1056, v8
  v_lshl_add_u32 v193, v180, 8, v193
  v_lshl_add_u32 v193, v7, 3, v193
  v_and_b32 v9, 16, v1
  v_lshl_add_u32 v193, v9, 3, v193
  s_lshl_b32 s10, s100, 2
  s_add_u32 s10, s10, s79
  s_lshl_b32 s11, s6, 7
  s_add_u32 s10, s10, s11
  s_lshl_b32 s12, s10, 11
  s_add_u32 s12, s12, 1048576
  s_lshl_b32 s13, s10, 7
  s_add_u32 s13, s13, 524288
  v_and_b32 v9, 7, v1
  v_lshlrev_b32 v186, 8, v9
  v_lshl_add_u32 v186, v180, 4, v186
  v_and_b32 v187, 16, v1
  v_lshrrev_b32 v184, 3, v1
  v_lshlrev_b32 v184, 12, v184
  v_lshl_add_u32 v184, v9, 4, v184
  v_lshlrev_b32 v4, 1, v9
  v_lshl_add_u32 v4, v187, 3, v4
  s_add_u32 s81, s81, 0x9e3779b9
  v_mov_b32 v13, s81
  v_mov_b32 v15, s81
  s_lshl_b32 s36, s8, 17
  s_add_u32 s36, s36, 2097152
  s_lshl_b32 s14, s79, 15
  s_add_u32 s14, s14, s36
  s_lshl_b32 s10, s100, 7
  s_add_u32 s14, s14, s10
  s_lshl_b32 s10, s100, 12
  s_add_u32 s36, s36, s10
  s_lshr_b32 s37, s100, 3
  s_lshl_b32 s37, s37, 11
  s_lshl_b32 s10, s8, 8
  s_add_u32 s37, s37, s10
  s_and_b32 s10, s100, 7
  s_lshl_b32 s10, s10, 4
  s_add_u32 s37, s37, s10
  s_mul_i32 s10, s79, 2112
  s_add_u32 s10, s10, 7040
  v_lshl_add_u32 v10, v180, 1, 0
  v_xor_b32 v10, v10, v1
  v_lshl_add_u32 v188, v10, 4, s10
  v_lshl_add_u32 v10, v180, 1, 8
  v_xor_b32 v10, v10, v1
  v_lshl_add_u32 v189, v10, 4, s10
  v_lshlrev_b32 v10, 1, v9
  v_xor_b32 v10, v10, v180
  v_lshlrev_b32 v10, 4, v10
  v_lshl_add_u32 v10, v9, 8, v10
  v_xor_b32 v6, 0, v10
  v_add_u32 v80, s10, v6
  v_xor_b32 v6, 64, v10
  v_add_u32 v81, s10, v6
  v_xor_b32 v6, 128, v10
  v_add_u32 v82, s10, v6
  v_xor_b32 v6, 192, v10
  v_add_u32 v83, s10, v6
  v_lshlrev_b32 v190, 2, v9
  v_add_u32 v191, s10, v190
  v_add_u32 v192, s10, v187
  s_mov_b32 s39, 1
  s_mov_b32 s82, 1
  s_mov_b32 s44, 0
  s_mov_b32 s45, -1
  s_add_u32 s15, s6, 1
  s_cmp_lg_u32 s3, 4
  s_cbranch_scc1 L_tail
L_wrm:
  ds_read_b32 v11, v182 offset:12
  s_add_u32 s80, s80, 1
  s_waitcnt lgkmcnt(0)
  v_readfirstlane_b32 s10, v11
  s_cmp_ge_u32 s80, 16777216
  s_cbranch_scc1 L_wrm_ok
  s_cmp_ge_i32 s10, 2
  s_cbranch_scc1 L_wrm_ok
  s_sleep 8
  s_branch L_wrm
L_wrm_ok:
  s_mov_b32 s66, 0
  s_mov_b32 s74, 0
  s_mov_b32 s80, 16777216
  s_mov_b32 s82, 0
  s_branch L_tail
L_warmed:
  s_mov_b32 s80, 0
  s_mov_b32 s82, 1
  s_mov_b64 exec, -1
  s_mov_b32 s66, 3145728
  s_mov_b32 s74, 8192
L_tail:
  s_cmp_lg_u32 s3, 6
  s_cbranch_scc1 L_nochk
  s_mov_b32 s42, 0
  s_add_u32 s10, s4, s8
  s_and_b32 s10, s10, 7
  s_lshl_b32 s11, s7, 3
  s_add_u32 s10, s10, s11
  s_mul_i32 s83, s10, 4352
  s_add_u32 s83, s83, 327680
L_ck0:
  ds_read_b32 v11, v182 offset:0
  s_add_u32 s80, s80, 1
  s_waitcnt lgkmcnt(0)
  v_readfirstlane_b32 s10, v11
  s_cmp_ge_u32 s80, 16777216
  s_cbranch_scc1 L_ck0_ok
  s_cmp_ge_i32 s10, 11
  s_cbranch_scc1 L_ck0_ok
  s_sleep 2
  s_branch L_ck0
L_ck0_ok:
  s_mov_b64 exec, 1
  v_mov_b32 v10, 1
  buffer_atomic_add v10, v182, s[64:67], s83 offen offset:4 sc0 sc1
  s_waitcnt vmcnt(0)
  v_add_u32 v10, 1, v10
  v_cmp_ge_u32 vcc, 8, v10
  s_nop 1
  v_cndmask_b32 v10, 0, v10, vcc
  ds_write_b32 v182, v10 offset:56
  s_mov_b64 exec, -1
L_cb0_x:
L_ck1:
  ds_read_b32 v11, v182 offset:0
  s_add_u32 s80, s80, 1
  s_waitcnt lgkmcnt(0)
  v_readfirstlane_b32 s10, v11
  s_cmp_ge_u32 s80, 16777216
  s_cbranch_scc1 L_ck1_ok
  s_cmp_ge_i32 s10, 20
  s_cbranch_scc1 L_ck1_ok
  s_sleep 2
  s_branch L_ck1
L_ck1_ok:
  s_mov_b64 exec, 1
  v_mov_b32 v10, 1
  buffer_atomic_add v10, v182, s[64:67], s83 offen offset:8 sc0 sc1
  s_waitcnt vmcnt(0)
  v_add_u32 v10, 1, v10
  v_cmp_ge_u32 vcc, 8, v10
  s_nop 1
  v_cndmask_b32 v10, 0, v10, vcc
  ds_write_b32 v182, v10 offset:56
  s_mov_b64 exec, -1
L_cb1:
  ds_read_b32 v11, v182 offset:0
  s_add_u32 s80, s80, 1
  s_waitcnt lgkmcnt(0)
  v_readfirstlane_b32 s10, v11
  s_cmp_ge_u32 s80, 16777216
  s_cbranch_scc1 L_cb1_ok
  s_cmp_ge_i32 s10, 32
  s_cbranch_scc1 L_cb1_ok
  s_sleep 4
  s_branch L_cb1
L_cb1_ok:
  ds_write_b32 v182, v182 offset:56
L_cb1_x:
L_ck2:
  ds_read_b32 v11, v182 offset:0
  s_add_u32 s80, s80, 1
  s_waitcnt lgkmcnt(0)
  v_readfirstlane_b32 s10, v11
  s_cmp_ge_u32 s80, 16777216
  s_cbranch_scc1 L_ck2_ok
  s_cmp_ge_i32 s10, 52
  s_cbranch_scc1 L_ck2_ok
  s_sleep 2
  s_branch L_ck2
L_ck2_ok:
  s_mov_b64 exec, 1
  v_mov_b32 v10, 1
  buffer_atomic_add v10, v182, s[64:67], s83 offen offset:12 sc0 sc1
  s_waitcnt vmcnt(0)
  v_add_u32 v10, 1, v10
  v_cmp_ge_u32 vcc, 8, v10
  s_nop 1
  v_cndmask_b32 v10, 0, v10, vcc
  ds_write_b32 v182, v10 offset:56
  s_mov_b64 exec, -1
L_cb2:
  ds_read_b32 v11, v182 offset:0
  s_add_u32 s80, s80, 1
  s_waitcnt lgkmcnt(0)
  v_readfirstlane_b32 s10, v11
  s_cmp_ge_u32 s80, 16777216
  s_cbranch_scc1 L_cb2_ok
  s_cmp_ge_i32 s10, 64
  s_cbranch_scc1 L_cb2_ok
  s_sleep 4
  s_branch L_cb2
L_cb2_ok:
  ds_write_b32 v182, v182 offset:56
L_cb2_x:
L_ck3:
  ds_read_b32 v11, v182 offset:0
  s_add_u32 s80, s80, 1
  s_waitcnt lgkmcnt(0)
  v_readfirstlane_b32 s10, v11
  s_cmp_ge_u32 s80, 16777216
  s_cbranch_scc1 L_ck3_ok
  s_cmp_ge_i32 s10, 82
  s_cbranch_scc1 L_ck3_ok
  s_sleep 2
  s_branch L_ck3
L_ck3_ok:
  s_mov_b64 exec, 1
  v_mov_b32 v10, 1
  buffer_atomic_add v10, v182, s[64:67], s83 offen offset:16 sc0 sc1
  s_waitcnt vmcnt(0)
  v_add_u32 v10, 1, v10
  v_cmp_ge_u32 vcc, 8, v10
  s_nop 1
  v_cndmask_b32 v10, 0, v10, vcc
  ds_write_b32 v182, v10 offset:56
  s_mov_b64 exec, -1
L_cb3:
  ds_read_b32 v11, v182 offset:0
  s_add_u32 s80, s80, 1
  s_waitcnt lgkmcnt(0)
  v_readfirstlane_b32 s10, v11
  s_cmp_ge_u32 s80, 16777216
  s_cbranch_scc1 L_cb3_ok
  s_cmp_ge_i32 s10, 94
  s_cbranch_scc1 L_cb3_ok
  s_sleep 4
  s_branch L_cb3
L_cb3_ok:
  ds_write_b32 v182, v182 offset:56
L_cb3_x:
L_ck4:
  ds_read_b32 v11, v182 offset:0
  s_add_u32 s80, s80, 1
  s_waitcnt lgkmcnt(0)
  v_readfirstlane_b32 s10, v11
  s_cmp_ge_u32 s80, 16777216
  s_cbranch_scc1 L_ck4_ok
  s_cmp_ge_i32 s10, 110
  s_cbranch_scc1 L_ck4_ok
  s_sleep 2
  s_branch L_ck4
L_ck4_ok:
  s_mov_b64 exec, 1
  v_mov_b32 v10, 1
  buffer_atomic_add v10, v182, s[64:67], s83 offen offset:20 sc0 sc1
  s_waitcnt vmcnt(0)
  v_add_u32 v10, 1, v10
  v_cmp_ge_u32 vcc, 8, v10
  s_nop 1
  v_cndmask_b32 v10, 0, v10, vcc
  ds_write_b32 v182, v10 offset:56
  s_mov_b64 exec, -1
L_cb4:
  ds_read_b32 v11, v182 offset:0
  s_add_u32 s80, s80, 1
  s_waitcnt lgkmcnt(0)
  v_readfirstlane_b32 s10, v11
  s_cmp_ge_u32 s80, 16777216
  s_cbranch_scc1 L_cb4_ok
  s_cmp_ge_i32 s10, 122
  s_cbranch_scc1 L_cb4_ok
  s_sleep 4
  s_branch L_cb4
L_cb4_ok:
  ds_write_b32 v182, v182 offset:56
L_cb4_x:
L_nochk:
L_pubw:
  ds_read_b32 v11, v182 offset:36
  s_add_u32 s80, s80, 1
  s_waitcnt lgkmcnt(0)
  v_readfirstlane_b32 s10, v11
  s_cmp_ge_u32 s80, 16777216
  s_cbranch_scc1 L_pubw_ok
  s_cmp_ge_i32 s10, 1
  s_cbranch_scc1 L_pubw_ok
  s_sleep 1
  s_branch L_pubw
L_pubw_ok:
  s_lshl_b32 s10, s79, 10
  s_add_u32 s10, s10, s36
  buffer_load_dwordx4 v[52:55], v3, s[64:67], s10 offen sc1
  ds_read_b32 v9, v182 offset:40
  s_waitcnt lgkmcnt(0)
  v_readfirstlane_b32 s39, v9
L_waw:
  ds_read_b32 v11, v182 offset:16
  s_add_u32 s80, s80, 1
  s_waitcnt lgkmcnt(0)
  v_readfirstlane_b32 s10, v11
  s_cmp_ge_u32 s80, 16777216
  s_cbranch_scc1 L_waw_ok
  s_cmp_ge_i32 s10, 1
  s_cbranch_scc1 L_waw_ok
  s_branch L_waw
L_waw_ok:
  v_add_u32 v196, s10, v193
  v_xor_b32 v197, 32, v196
  v_xor_b32 v198, 64, v196
  v_xor_b32 v199, 96, v196
  v_xor_b32 v200, 128, v196
  v_xor_b32 v201, 160, v196
  v_xor_b32 v202, 192, v196
  v_xor_b32 v203, 224, v196
  ds_read_b64_tr_b16 v[116:117], v196 offset:0
  ds_read_b64_tr_b16 v[118:119], v200 offset:0
  ds_read_b64_tr_b16 v[132:133], v197 offset:0
  ds_read_b64_tr_b16 v[134:135], v201 offset:0
  ds_read_b64_tr_b16 v[148:149], v198 offset:0
  ds_read_b64_tr_b16 v[150:151], v202 offset:0
  ds_read_b64_tr_b16 v[164:165], v199 offset:0
  ds_read_b64_tr_b16 v[166:167], v203 offset:0
  ds_read_b64_tr_b16 v[120:121], v196 offset:4096
  ds_read_b64_tr_b16 v[122:123], v200 offset:4096
  ds_read_b64_tr_b16 v[136:137], v197 offset:4096
  ds_read_b64_tr_b16 v[138:139], v201 offset:4096
  ds_read_b64_tr_b16 v[152:153], v198 offset:4096
  ds_read_b64_tr_b16 v[154:155], v202 offset:4096
  ds_read_b64_tr_b16 v[168:169], v199 offset:4096
  ds_read_b64_tr_b16 v[170:171], v203 offset:4096
  ds_read_b64_tr_b16 v[124:125], v196 offset:8192
  ds_read_b64_tr_b16 v[126:127], v200 offset:8192
  ds_read_b64_tr_b16 v[140:141], v197 offset:8192
  ds_read_b64_tr_b16 v[142:143], v201 offset:8192
  ds_read_b64_tr_b16 v[156:157], v198 offset:8192
  ds_read_b64_tr_b16 v[158:159], v202 offset:8192
  ds_read_b64_tr_b16 v[172:173], v199 offset:8192
  ds_read_b64_tr_b16 v[174:175], v203 offset:8192
  ds_read_b64_tr_b16 v[128:129], v196 offset:12288
  ds_read_b64_tr_b16 v[130:131], v200 offset:12288
  ds_read_b64_tr_b16 v[144:145], v197 offset:12288
  ds_read_b64_tr_b16 v[146:147], v201 offset:12288
  ds_read_b64_tr_b16 v[160:161], v198 offset:12288
  ds_read_b64_tr_b16 v[162:163], v202 offset:12288
  ds_read_b64_tr_b16 v[176:177], v199 offset:12288
  ds_read_b64_tr_b16 v[178:179], v203 offset:12288
L_pubw2:
  ds_read_b32 v11, v182 offset:36
  s_add_u32 s80, s80, 1
  s_waitcnt lgkmcnt(0)
  v_readfirstlane_b32 s10, v11
  s_cmp_ge_u32 s80, 16777216
  s_cbranch_scc1 L_pubw2_ok
  s_cmp_ge_i32 s10, s15
  s_cbranch_scc1 L_pubw2_ok
  s_branch L_pubw2
L_pubw2_ok:
  buffer_load_dwordx4 v[56:59], v3, s[64:67], s12 offen offset:0 sc1
  buffer_load_dwordx4 v[60:63], v3, s[64:67], s12 offen offset:1024 sc1
  buffer_load_dword v64, v190, s[64:67], s13 offen sc1
L_wbw:
  ds_read_b32 v11, v182 offset:44
  s_add_u32 s80, s80, 1
  s_waitcnt lgkmcnt(0)
  v_readfirstlane_b32 s10, v11
  s_cmp_ge_u32 s80, 16777216
  s_cbranch_scc1 L_wbw_ok
  s_cmp_ge_i32 s10, 1
  s_cbranch_scc1 L_wbw_ok
  s_branch L_wbw
L_wbw_ok:
  v_add_u32 v196, s10, v193
  v_xor_b32 v197, 32, v196
  v_xor_b32 v198, 64, v196
  v_xor_b32 v199, 96, v196
  v_xor_b32 v200, 128, v196
  v_xor_b32 v201, 160, v196
  v_xor_b32 v202, 192, v196
  v_xor_b32 v203, 224, v196
  ds_read_b64_tr_b16 v[204:205], v196 offset:0
  ds_read_b64_tr_b16 v[206:207], v200 offset:0
  ds_read_b64_tr_b16 v[220:221], v197 offset:0
  ds_read_b64_tr_b16 v[222:223], v201 offset:0
  ds_read_b64_tr_b16 v[236:237], v198 offset:0
  ds_read_b64_tr_b16 v[238:239], v202 offset:0
  ds_read_b64_tr_b16 v[252:253], v199 offset:0
  ds_read_b64_tr_b16 v[254:255], v203 offset:0
  ds_read_b64_tr_b16 v[208:209], v196 offset:4096
  ds_read_b64_tr_b16 v[210:211], v200 offset:4096
  ds_read_b64_tr_b16 v[224:225], v197 offset:4096
  ds_read_b64_tr_b16 v[226:227], v201 offset:4096
  ds_read_b64_tr_b16 v[240:241], v198 offset:4096
  ds_read_b64_tr_b16 v[242:243], v202 offset:4096
  ds_read_b64_tr_b16 v[104:105], v199 offset:4096
  ds_read_b64_tr_b16 v[106:107], v203 offset:4096
  ds_read_b64_tr_b16 v[212:213], v196 offset:8192
  ds_read_b64_tr_b16 v[214:215], v200 offset:8192
  ds_read_b64_tr_b16 v[228:229], v197 offset:8192
  ds_read_b64_tr_b16 v[230:231], v201 offset:8192
  ds_read_b64_tr_b16 v[244:245], v198 offset:8192
  ds_read_b64_tr_b16 v[246:247], v202 offset:8192
  ds_read_b64_tr_b16 v[108:109], v199 offset:8192
  ds_read_b64_tr_b16 v[110:111], v203 offset:8192
  ds_read_b64_tr_b16 v[216:217], v196 offset:12288
  ds_read_b64_tr_b16 v[218:219], v200 offset:12288
  ds_read_b64_tr_b16 v[232:233], v197 offset:12288
  ds_read_b64_tr_b16 v[234:235], v201 offset:12288
  ds_read_b64_tr_b16 v[248:249], v198 offset:12288
  ds_read_b64_tr_b16 v[250:251], v202 offset:12288
  ds_read_b64_tr_b16 v[112:113], v199 offset:12288
  ds_read_b64_tr_b16 v[114:115], v203 offset:12288
L_bchk:
  s_add_u32 s80, s80, 16
  s_waitcnt vmcnt(0)
  v_max3_u32 v8, v56, v57, v58
  v_max3_u32 v9, v59, v60, v61
  v_max3_u32 v8, v8, v62, v63
  v_max3_u32 v8, v8, v9, v64
  v_cmp_eq_u32 vcc, -1, v8
  s_cmp_ge_u32 s80, 16777216
  s_cbranch_scc1 L_bok
  s_cbranch_vccz L_bok
  s_mov_b64 exec, vcc
  s_sleep 3
  buffer_load_dwordx4 v[56:59], v3, s[64:67], s12 offen offset:0 sc1
  buffer_load_dwordx4 v[60:63], v3, s[64:67], s12 offen offset:1024 sc1
  buffer_load_dword v64, v190, s[64:67], s13 offen sc1
  s_branch L_bchk
L_bok:
  s_mov_b64 exec, -1
  ds_write_b128 v188, v[56:59]
  ds_write_b128 v189, v[60:63] offset:1024
  ds_write_b32 v191, v64 offset:2048
  ds_read_b128 v[84:87], v192 offset:2048
  ds_read_b128 v[36:39], v80
  ds_read_b128 v[40:43], v81
  ds_read_b128 v[44:47], v82
  ds_read_b128 v[48:51], v83
  s_waitcnt lgkmcnt(0)
  v_mfma_f32_16x16x32_bf16 v[20:23], v[36:39], v[116:119], 0
  v_max3_f32 v8, v84, v85, v86
  v_max_f32 v8, v8, v87
  v_mfma_f32_16x16x32_bf16 v[24:27], v[36:39], v[132:135], 0
  v_mov_b32 v9, v8
  s_nop 0
  v_mfma_f32_16x16x32_bf16 v[28:31], v[36:39], v[148:151], 0
  s_nop 0
  v_permlane16_swap_b32 v8, v9
  v_mfma_f32_16x16x32_bf16 v[32:35], v[36:39], v[164:167], 0
  s_nop 0
  v_max_f32 v8, v8, v9
  v_mfma_f32_16x16x32_bf16 v[20:23], v[40:43], v[120:123], v[20:23]
  v_sub_f32 v84, v84, v8
  v_sub_f32 v85, v85, v8
  v_mfma_f32_16x16x32_bf16 v[24:27], v[40:43], v[136:139], v[24:27]
  v_sub_f32 v86, v86, v8
  v_sub_f32 v87, v87, v8
  v_mfma_f32_16x16x32_bf16 v[28:31], v[40:43], v[152:155], v[28:31]
  v_exp_f32 v84, v84
  v_exp_f32 v85, v85
  v_mfma_f32_16x16x32_bf16 v[32:35], v[40:43], v[168:171], v[32:35]
  v_exp_f32 v86, v86
  v_exp_f32 v87, v87
  v_mfma_f32_16x16x32_bf16 v[20:23], v[44:47], v[124:127], v[20:23]
  s_nop 0
  v_add_f32 v8, v84, v85
  v_mfma_f32_16x16x32_bf16 v[24:27], v[44:47], v[140:143], v[24:27]
  v_add_f32 v9, v86, v87
  v_add_f32 v8, v8, v9
  v_mfma_f32_16x16x32_bf16 v[28:31], v[44:47], v[156:159], v[28:31]
  v_mov_b32 v9, v8
  s_nop 0
  v_mfma_f32_16x16x32_bf16 v[32:35], v[44:47], v[172:175], v[32:35]
  s_nop 0
  v_permlane16_swap_b32 v8, v9
  v_mfma_f32_16x16x32_bf16 v[20:23], v[48:51], v[128:131], v[20:23]
  s_nop 0
  v_add_f32 v8, v8, v9
  v_mfma_f32_16x16x32_bf16 v[24:27], v[48:51], v[144:147], v[24:27]
  v_rcp_f32 v8, v8
  v_mfma_f32_16x16x32_bf16 v[28:31], v[48:51], v[160:163], v[28:31]
  v_mfma_f32_16x16x32_bf16 v[32:35], v[48:51], v[176:179], v[32:35]
  v_mfma_f32_16x16x32_bf16 v[88:91], v[36:39], v[204:207], 0
  s_nop 1
  v_mfma_f32_16x16x32_bf16 v[92:95], v[36:39], v[220:223], 0
  s_nop 1
  v_mfma_f32_16x16x32_bf16 v[96:99], v[36:39], v[236:239], 0
  s_nop 1
  v_mfma_f32_16x16x32_bf16 v[100:103], v[36:39], v[252:255], 0
  v_mul_f32 v20, v20, v84
  v_mul_f32 v24, v24, v84
  v_mfma_f32_16x16x32_bf16 v[88:91], v[40:43], v[208:211], v[88:91]
  v_mul_f32 v28, v28, v84
  v_mul_f32 v32, v32, v84
  v_mfma_f32_16x16x32_bf16 v[92:95], v[40:43], v[224:227], v[92:95]
  v_fmac_f32 v20, v21, v85
  v_fmac_f32 v24, v25, v85
  v_mfma_f32_16x16x32_bf16 v[96:99], v[40:43], v[240:243], v[96:99]
  v_fmac_f32 v28, v29, v85
  v_fmac_f32 v32, v33, v85
  v_mfma_f32_16x16x32_bf16 v[100:103], v[40:43], v[104:107], v[100:103]
  v_fmac_f32 v20, v22, v86
  v_fmac_f32 v24, v26, v86
  v_mfma_f32_16x16x32_bf16 v[88:91], v[44:47], v[212:215], v[88:91]
  v_fmac_f32 v28, v30, v86
  v_fmac_f32 v32, v34, v86
  v_mfma_f32_16x16x32_bf16 v[92:95], v[44:47], v[228:231], v[92:95]
  v_fmac_f32 v20, v23, v87
  v_fmac_f32 v24, v27, v87
  v_mfma_f32_16x16x32_bf16 v[96:99], v[44:47], v[244:247], v[96:99]
  v_fmac_f32 v28, v31, v87
  v_fmac_f32 v32, v35, v87
  v_mfma_f32_16x16x32_bf16 v[100:103], v[44:47], v[108:111], v[100:103]
  s_nop 0
  v_permlane16_swap_b32 v20, v24
  v_mfma_f32_16x16x32_bf16 v[88:91], v[48:51], v[216:219], v[88:91]
  v_permlane16_swap_b32 v28, v32
  s_nop 0
  v_mfma_f32_16x16x32_bf16 v[92:95], v[48:51], v[232:235], v[92:95]
  v_add_f32 v20, v20, v24
  v_add_f32 v28, v28, v32
  v_mfma_f32_16x16x32_bf16 v[96:99], v[48:51], v[248:251], v[96:99]
  v_cndmask_b32 v20, v20, v28, s[44:45]
  v_mul_f32 v12, v20, v8
  v_mfma_f32_16x16x32_bf16 v[100:103], v[48:51], v[112:115], v[100:103]
  s_nop 4
  v_mul_f32 v88, v88, v84
  v_mul_f32 v92, v92, v84
  v_mul_f32 v96, v96, v84
  v_mul_f32 v100, v100, v84
  v_fmac_f32 v88, v89, v85
  v_fmac_f32 v92, v93, v85
  v_fmac_f32 v96, v97, v85
  v_fmac_f32 v100, v101, v85
  v_fmac_f32 v88, v90, v86
  v_fmac_f32 v92, v94, v86
  v_fmac_f32 v96, v98, v86
  v_fmac_f32 v100, v102, v86
  v_fmac_f32 v88, v91, v87
  v_fmac_f32 v92, v95, v87
  v_fmac_f32 v96, v99, v87
  v_fmac_f32 v100, v103, v87
  s_nop 0
  v_permlane16_swap_b32 v88, v92
  v_permlane16_swap_b32 v96, v100
  s_nop 0
  v_add_f32 v88, v88, v92
  v_add_f32 v96, v96, v100
  v_cndmask_b32 v88, v88, v96, s[44:45]
  v_mul_f32 v14, v88, v8
  s_cmp_eq_u32 s39, 0
  s_cbranch_scc1 L_far
  buffer_store_dwordx4 v[12:15], v184, s[64:67], s14 offen
  s_cmp_lg_u32 s3, 4
  s_cbranch_scc1 L_end
  s_sleep 4
  s_branch L_rpoll
L_far:
  buffer_store_dwordx4 v[12:15], v184, s[64:67], s14 offen sc1
  s_cmp_lg_u32 s3, 4
  s_cbranch_scc1 L_end
  s_sleep 18
L_rpoll:
  buffer_load_dwordx4 v[52:55], v3, s[64:67], s36 offen offset:0 sc1
  buffer_load_dwordx4 v[56:59], v3, s[64:67], s36 offen offset:1024 sc1
  buffer_load_dwordx4 v[60:63], v3, s[64:67], s36 offen offset:2048 sc1
  buffer_load_dwordx4 v[64:67], v3, s[64:67], s36 offen offset:3072 sc1
  s_add_u32 s80, s80, 16
  s_waitcnt vmcnt(0)
  v_xor_b32 v68, s81, v53
  v_xor_b32 v69, s81, v55
  v_xor_b32 v70, s81, v57
  v_xor_b32 v71, s81, v59
  v_xor_b32 v72, s81, v61
  v_xor_b32 v73, s81, v63
  v_xor_b32 v74, s81, v65
  v_xor_b32 v75, s81, v67
  v_or3_b32 v8, v68, v69, v70
  v_or3_b32 v9, v71, v72, v73
  v_or3_b32 v8, v8, v74, v75
  v_or_b32 v8, v8, v9
  v_cmp_ne_u32 vcc, 0, v8
  s_cmp_ge_u32 s80, 16777216
  s_cbranch_scc1 L_rok
  s_cbranch_vccz L_rok
  s_bcnt1_i32_b64 s10, vcc
  s_mov_b64 exec, vcc
  s_branch L_rpoll
L_rok:
  s_mov_b64 exec, -1
  v_add_f32 v52, v52, v56
  v_add_f32 v60, v60, v64
  v_add_f32 v54, v54, v58
  v_add_f32 v62, v62, v66
  v_add_f32 v52, v52, v60
  v_add_f32 v54, v54, v62
  s_nop 0
  v_add_f32_dpp v52, v52, v52 row_ror:8 row_mask:0xf bank_mask:0xf
  v_add_f32_dpp v54, v54, v54 row_ror:8 row_mask:0xf bank_mask:0xf
  s_nop 1
  v_permlane16_swap_b32 v52, v54
  s_nop 0
  v_add_f32 v52, v52, v54
  v_mov_b32 v54, v52
  s_nop 1
  v_permlane32_swap_b32 v52, v54
  s_nop 0
  v_add_f32 v52, v52, v54
  s_nop 1
  v_mov_b32_dpp v54, v52 quad_perm:[1,1,3,3] row_mask:0xf bank_mask:0xf
  v_cvt_pk_bf16_f32 v8, v52, v54
  s_mov_b64 exec, 0x00550055
  buffer_store_dword v8, v4, s[72:75], s37 offen
  s_cmp_eq_u32 s82, 0
  s_cbranch_scc1 L_warmed
  s_cmp_lg_u32 s2, 0
  s_cbranch_scc1 L_noep
  s_mov_b64 exec, 1
  s_mov_b32 s11, 262144
  buffer_store_dword v13, v182, s[64:67], s11 offen
L_noep:
  s_endpgm
L_helper:
  s_setprio 3
  s_load_dword s81, s[40:41], 0x40000
  v_lshlrev_b32 v10, 13, v180
  v_lshl_add_u32 v10, v181, 4, v10
  v_lshlrev_b32 v184, 9, v180
  s_lshl_b32 s36, s7, 3
  s_add_u32 s36, s36, s8
  s_lshl_b32 s36, s36, 8
  s_lshl_b32 s11, s4, 15
  s_add_u32 s36, s36, s11
  s_add_u32 s36, s36, 1048576
  s_lshl_b32 s37, s7, 7
  s_lshl_b32 s11, s8, 2
  s_add_u32 s37, s37, s11
  s_lshl_b32 s11, s4, 11
  s_add_u32 s37, s37, s11
  s_add_u32 s37, s37, 524288
  s_add_u32 s38, s36, 262144
  s_add_u32 s39, s37, 16384
  v_mov_b32 v52, -1
  v_mov_b32 v53, -1
  v_mov_b32 v54, -1
  v_mov_b32 v55, -1
  buffer_store_dwordx4 v[52:55], v10, s[64:67], s36 offen sc1
  buffer_store_dwordx4 v[52:55], v10, s[64:67], s38 offen sc1
  s_mov_b32 exec_lo, 0x00010001
  s_mov_b32 exec_hi, 0x00010001
  buffer_store_dword v52, v184, s[64:67], s37 offen sc1
  buffer_store_dword v52, v184, s[64:67], s39 offen sc1
L_ablc:
  s_cmp_lg_u32 s8, 0
  s_cbranch_scc1 L_nocnt
  s_mov_b64 exec, 15
  v_mov_b32 v56, 0
  v_mov_b32 v57, 0
  v_mov_b32 v58, 0
  v_mov_b32 v59, 0
  buffer_store_dwordx4 v[56:59], v3, s[64:67], s83 offen sc1
L_nocnt:
  s_mov_b64 exec, -1
  s_barrier
  v_lshl_add_u32 v6, v8, 2, v180
  v_lshlrev_b32 v6, 5, v6
  v_lshl_add_u32 v6, v7, 2, v6
  v_lshlrev_b32 v8, 14, v180
  v_lshl_add_u32 v8, v181, 3, v8
  s_lshl_b32 s12, s4, 11
  s_lshl_b32 s13, s6, 16
  s_add_u32 s13, s13, s12
  s_lshl_b32 s11, s5, 7
  s_add_u32 s13, s13, s11
  s_lshl_b32 s11, s7, 14
  s_add_u32 s12, s12, s11
  v_lshlrev_b32 v185, 3, v1
  v_add_u32 v185, 640, v185
  s_waitcnt lgkmcnt(0)
  s_add_u32 s81, s81, 0x9e3779b9
  v_mov_b32 v13, s81
  v_mov_b32 v15, s81
L_qcnt:
  ds_read_b32 v11, v182 offset:48
  s_add_u32 s80, s80, 1
  s_waitcnt lgkmcnt(0)
  v_readfirstlane_b32 s10, v11
  s_cmp_ge_u32 s80, 16777216
  s_cbranch_scc1 L_qcnt_ok
  s_cmp_ge_i32 s10, 4
  s_cbranch_scc1 L_qcnt_ok
  s_branch L_qcnt
L_qcnt_ok:
  ds_read_b32 v84, v6 offset:7040
  ds_read_b32 v85, v6 offset:7056
  ds_read_b32 v86, v6 offset:7552
  ds_read_b32 v87, v6 offset:7568
  ds_read_b32 v88, v6 offset:8064
  ds_read_b32 v89, v6 offset:8080
  ds_read_b32 v90, v6 offset:8576
  ds_read_b32 v91, v6 offset:8592
  s_waitcnt lgkmcnt(0)
  v_add_f32 v84, v84, v86
  v_add_f32 v88, v88, v90
  v_add_f32 v85, v85, v87
  v_add_f32 v89, v89, v91
  v_add_f32 v84, v84, v88
  v_add_f32 v85, v85, v89
  v_cvt_pk_bf16_f32 v12, v84, v85
  s_nop 1
  v_mov_b32_dpp v14, v12 quad_perm:[1,1,3,3] row_mask:0xf bank_mask:0xf
  s_mov_b32 exec_lo, 0x55555555
  s_mov_b32 exec_hi, 0x55555555
  s_waitcnt vmcnt(0)
  buffer_store_dwordx4 v[12:15], v8, s[64:67], s13 offen sc1
  s_mov_b64 exec, 1
  s_getreg_b32 s14, hwreg(HW_REG_XCC_ID, 0, 4)
  v_mov_b32 v20, s14
  v_mov_b32 v21, s81
  s_lshl_b32 s42, s8, 8
  s_add_u32 s42, s42, 266240
  s_lshl_b32 s10, s100, 3
  s_add_u32 s10, s10, s42
  buffer_store_dwordx2 v[20:21], v182, s[64:67], s10 offen sc1
  s_mov_b64 exec, -1
L_qpass:
  s_sleep 48
L_qpoll:
  buffer_load_dwordx4 v[116:119], v3, s[64:67], s12 offen sc1
  buffer_load_dwordx4 v[120:123], v3, s[64:67], s12 offen offset:1024 sc1
  s_add_u32 s80, s80, 16
  s_waitcnt vmcnt(0)
  v_xor_b32 v9, s81, v117
  v_xor_b32 v8, s81, v119
  v_xor_b32 v11, s81, v121
  v_xor_b32 v7, s81, v123
  v_or3_b32 v9, v9, v8, v11
  v_or_b32 v9, v9, v7
  v_cmp_ne_u32 vcc, 0, v9
  s_cmp_ge_u32 s80, 16777216
  s_cbranch_scc1 L_qok
  s_cbranch_vccz L_qok
  s_mov_b64 exec, vcc
  s_sleep 12
  s_branch L_qpoll
L_qok:
  s_mov_b64 exec, -1
  ds_write2_b32 v185, v116, v118 offset0:0 offset1:1
  ds_write2_b32 v185, v120, v122 offset0:128 offset1:129
  s_mov_b64 exec, 1
  ds_add_u32 v182, v183 offset:12
  s_mov_b64 exec, -1
  s_cmp_lg_u32 s82, 0
  s_cbranch_scc1 L_qdone
  s_mov_b32 s82, 1
  s_add_u32 s12, s12, 65536
  v_add_u32 v185, 1024, v185
  s_waitcnt lgkmcnt(0)
  s_branch L_qpass
L_qdone:
  s_mov_b64 exec, 0xffff
L_xpoll:
  s_sleep 60
  buffer_load_dwordx4 v[116:119], v3, s[64:67], s42 offen sc1
  s_add_u32 s80, s80, 16
  s_waitcnt vmcnt(0)
  v_xor_b32 v9, s81, v117
  v_xor_b32 v8, s81, v119
  v_or_b32 v9, v9, v8
  v_cmp_ne_u32 vcc, 0, v9
  s_cmp_ge_u32 s80, 16777216
  s_cbranch_scc1 L_xdone
  s_cbranch_vccnz L_xpoll
  v_xor_b32 v9, s14, v116
  v_xor_b32 v8, s14, v118
  v_or_b32 v9, v9, v8
  v_cmp_ne_u32 vcc, 0, v9
  s_cbranch_vccnz L_xdone
  s_mov_b64 exec, 1
  ds_add_u32 v182, v183 offset:40
  s_mov_b64 exec, -1
L_xdone:
  s_mov_b64 exec, -1
  v_lshlrev_b32 v6, 5, v1
  v_lshl_add_u32 v6, v180, 4, v6
  v_lshlrev_b32 v7, 4, v180
  s_mov_b32 s15, 2
L_cpass:
L_slw:
  ds_read_b32 v11, v182 offset:32
  s_add_u32 s80, s80, 1
  s_waitcnt lgkmcnt(0)
  v_readfirstlane_b32 s10, v11
  s_cmp_ge_u32 s80, 16777216
  s_cbranch_scc1 L_slw_ok
  s_cmp_ge_i32 s10, s15
  s_cbranch_scc1 L_slw_ok
  s_branch L_slw
L_slw_ok:
  ds_read_b128 v[84:87], v7 offset:64
  ds_read_b128 v[116:119], v6 offset:2688
  ds_read_b128 v[120:123], v6 offset:2704
  ds_read_b128 v[124:127], v6 offset:4864
  ds_read_b128 v[128:131], v6 offset:4880
  s_waitcnt lgkmcnt(4)
  v_max_f32 v4, v84, v86
  v_sub_f32 v84, v84, v4
  v_sub_f32 v86, v86, v4
  v_mul_f32 v84, s76, v84
  v_mul_f32 v86, s76, v86
  v_exp_f32 v84, v84
  v_exp_f32 v86, v86
  v_mul_f32 v4, s76, v4
  v_mul_f32 v5, v84, v85
  v_fmac_f32 v5, v86, v87
  v_rcp_f32 v8, v5
  v_log_f32 v5, v5
  v_mul_f32 v84, v84, v8
  v_mul_f32 v86, v86, v8
  v_add_f32 v4, v4, v5
  v_min_u32 v4, -2, v4
  s_waitcnt lgkmcnt(0)
  v_mul_f32 v116, v116, v84
  v_mul_f32 v117, v117, v84
  v_mul_f32 v118, v118, v84
  v_mul_f32 v119, v119, v84
  v_mul_f32 v120, v120, v84
  v_mul_f32 v121, v121, v84
  v_mul_f32 v122, v122, v84
  v_mul_f32 v123, v123, v84
  v_fmac_f32 v116, v124, v86
  v_fmac_f32 v117, v125, v86
  v_fmac_f32 v118, v126, v86
  v_fmac_f32 v119, v127, v86
  v_fmac_f32 v120, v128, v86
  v_fmac_f32 v121, v129, v86
  v_fmac_f32 v122, v130, v86
  v_fmac_f32 v123, v131, v86
  v_cvt_pk_bf16_f32 v12, v116, v117
  v_cvt_pk_bf16_f32 v13, v118, v119
  v_cvt_pk_bf16_f32 v14, v120, v121
  v_cvt_pk_bf16_f32 v15, v122, v123
  v_min_u32 v12, -2, v12
  v_min_u32 v13, -2, v13
  v_min_u32 v14, -2, v14
  v_min_u32 v15, -2, v15
  s_cmp_lg_u32 s15, 2
  s_cbranch_scc1 L_cst
  s_mov_b64 exec, 1
  ds_add_u32 v182, v183 offset:52
  s_mov_b64 exec, -1
L_hend:
  ds_read_b32 v11, v182 offset:4
  s_add_u32 s80, s80, 1
  s_waitcnt lgkmcnt(0)
  v_readfirstlane_b32 s10, v11
  s_cmp_ge_u32 s80, 16777216
  s_cbranch_scc1 L_hend_ok
  s_cmp_ge_i32 s10, 1
  s_cbranch_scc1 L_hend_ok
  s_sleep 1
  s_branch L_hend
L_hend_ok:
L_cst:
  buffer_store_dwordx4 v[12:15], v10, s[64:67], s36 offen sc1
  s_mov_b32 exec_lo, 0x00010001
  s_mov_b32 exec_hi, 0x00010001
  buffer_store_dword v4, v184, s[64:67], s37 offen sc1
  s_mov_b64 exec, 1
  ds_add_u32 v182, v183 offset:36
  s_mov_b64 exec, -1
  s_cmp_lg_u32 s15, 2
  s_cbranch_scc1 L_end
  s_mov_b32 s15, 4
  s_mov_b32 s36, s38
  s_mov_b32 s37, s39
  s_branch L_cpass
L_cons:
  s_setprio 2
  v_lshlrev_b32 v6, 2, v181
  ds_write_b32 v6, v182
  v_lshlrev_b32 v6, 2, v1
  ds_write_b32 v6, v182 offset:15488
  s_sub_u32 s15, s3, 1
  s_lshl_b32 s42, s15, 14
  s_add_u32 s42, s42, 32768
  s_lshl_b32 s10, s15, 2
  v_mov_b32 v2, s10
  v_lshlrev_b32 v6, 10, v7
  v_lshl_add_u32 v6, v8, 8, v6
  v_add_u32 v9, 0, v180
  v_xor_b32 v9, v9, v181
  v_lshl_add_u32 v186, v9, 4, v6
  v_add_u32 v9, 4, v180
  v_xor_b32 v9, v9, v181
  v_lshl_add_u32 v187, v9, 4, v6
  v_add_u32 v9, 8, v180
  v_xor_b32 v9, v9, v181
  v_lshl_add_u32 v188, v9, 4, v6
  v_add_u32 v9, 12, v180
  v_xor_b32 v9, v9, v181
  v_lshl_add_u32 v189, v9, 4, v6
  v_lshlrev_b32 v185, 4, v7
  v_lshl_add_u32 v185, v180, 6, v185
  s_waitcnt lgkmcnt(0)
  s_barrier
  s_mov_b32 s36, 32
L_cprob:
  v_mov_b32 v4, 0xff61b1e6
  v_mov_b32 v5, 0
  v_mov_b32 v52, 0
  v_mov_b32 v53, 0
  v_mov_b32 v54, 0
  v_mov_b32 v55, 0
  v_mov_b32 v56, 0
  v_mov_b32 v57, 0
  v_mov_b32 v58, 0
  v_mov_b32 v59, 0
  v_mov_b32 v60, 0
  v_mov_b32 v61, 0
  v_mov_b32 v62, 0
  v_mov_b32 v63, 0
  v_mov_b32 v64, 0
  v_mov_b32 v65, 0
  v_mov_b32 v66, 0
  v_mov_b32 v67, 0
  v_mov_b32 v68, 0
  v_mov_b32 v69, 0
  v_mov_b32 v70, 0
  v_mov_b32 v71, 0
  v_mov_b32 v72, 0
  v_mov_b32 v73, 0
  v_mov_b32 v74, 0
  v_mov_b32 v75, 0
  v_mov_b32 v76, 0
  v_mov_b32 v77, 0
  v_mov_b32 v78, 0
  v_mov_b32 v79, 0
  v_mov_b32 v80, 0
  v_mov_b32 v81, 0
  v_mov_b32 v82, 0
  v_mov_b32 v83, 0
  s_sub_u32 s37, s3, 1
  s_mov_b32 s14, 1
L_kloop:
  v_add_u32 v190, s42, v186
  v_add_u32 v191, s42, v187
  v_add_u32 v192, s42, v188
  v_add_u32 v193, s42, v189
  s_add_u32 s12, s15, 1
L_kland:
  ds_read_b32 v11, v182 offset:0
  s_add_u32 s80, s80, 1
  s_waitcnt lgkmcnt(0)
  v_readfirstlane_b32 s10, v11
  s_cmp_ge_u32 s80, 16777216
  s_cbranch_scc1 L_kland_ok
  s_cmp_ge_i32 s10, s12
  s_cbranch_scc1 L_kland_ok
  s_sleep 1
  s_branch L_kland
L_kland_ok:
  ds_read_b128 v[116:119], v190 offset:0
  ds_read_b128 v[120:123], v191 offset:0
  ds_read_b128 v[124:127], v192 offset:0
  ds_read_b128 v[128:131], v193 offset:0
  ds_read_b128 v[132:135], v190 offset:4096
  ds_read_b128 v[136:139], v191 offset:4096
  ds_read_b128 v[140:143], v192 offset:4096
  ds_read_b128 v[144:147], v193 offset:4096
  ds_read_b128 v[148:151], v190 offset:8192
  ds_read_b128 v[152:155], v191 offset:8192
  ds_read_b128 v[156:159], v192 offset:8192
  ds_read_b128 v[160:163], v193 offset:8192
  ds_read_b128 v[164:167], v190 offset:12288
  ds_read_b128 v[168:171], v191 offset:12288
  ds_read_b128 v[172:175], v192 offset:12288
  ds_read_b128 v[176:179], v193 offset:12288
  v_mov_b32 v6, s12
  s_waitcnt lgkmcnt(0)
  ds_write_b32 v2, v6 offset:24
  s_cmp_eq_u32 s14, 0
  s_cbranch_scc1 L_haveq
  s_mov_b32 s14, 0
  s_add_u32 s13, s82, 1
L_qwait:
  ds_read_b32 v11, v182 offset:12
  s_add_u32 s80, s80, 1
  s_waitcnt lgkmcnt(0)
  v_readfirstlane_b32 s10, v11
  s_cmp_ge_u32 s80, 16777216
  s_cbranch_scc1 L_qwait_ok
  s_cmp_ge_i32 s10, s13
  s_cbranch_scc1 L_qwait_ok
  s_sleep 1
  s_branch L_qwait
L_qwait_ok:
  v_lshlrev_b32 v6, 8, v1
  v_and_b32 v6, 0x300, v6
  v_lshl_add_u32 v6, v180, 4, v6
  s_lshl_b32 s10, s82, 10
  v_add_u32 v6, s10, v6
  ds_read_b128 v[36:39], v6 offset:640
  ds_read_b128 v[40:43], v6 offset:704
  ds_read_b128 v[44:47], v6 offset:768
  ds_read_b128 v[48:51], v6 offset:832
  s_waitcnt lgkmcnt(0)
L_haveq:
  v_mfma_f32_16x16x32_bf16 v[20:23], v[116:119], v[36:39], 0
  v_mfma_f32_16x16x32_bf16 v[24:27], v[132:135], v[36:39], 0
  v_mfma_f32_16x16x32_bf16 v[28:31], v[148:151], v[36:39], 0
  v_mfma_f32_16x16x32_bf16 v[32:35], v[164:167], v[36:39], 0
  v_mfma_f32_16x16x32_bf16 v[20:23], v[120:123], v[40:43], v[20:23]
  v_mfma_f32_16x16x32_bf16 v[24:27], v[136:139], v[40:43], v[24:27]
  v_mfma_f32_16x16x32_bf16 v[28:31], v[152:155], v[40:43], v[28:31]
  v_mfma_f32_16x16x32_bf16 v[32:35], v[168:171], v[40:43], v[32:35]
  v_mfma_f32_16x16x32_bf16 v[20:23], v[124:127], v[44:47], v[20:23]
  v_mfma_f32_16x16x32_bf16 v[24:27], v[140:143], v[44:47], v[24:27]
  v_mfma_f32_16x16x32_bf16 v[28:31], v[156:159], v[44:47], v[28:31]
  v_mfma_f32_16x16x32_bf16 v[32:35], v[172:175], v[44:47], v[32:35]
  v_mfma_f32_16x16x32_bf16 v[20:23], v[128:131], v[48:51], v[20:23]
  v_mfma_f32_16x16x32_bf16 v[24:27], v[144:147], v[48:51], v[24:27]
  v_mfma_f32_16x16x32_bf16 v[28:31], v[160:163], v[48:51], v[28:31]
  v_mfma_f32_16x16x32_bf16 v[32:35], v[176:179], v[48:51], v[32:35]
  s_lshl_b32 s10, s37, 9
  v_add_u32 v184, s10, v185
  s_lshl_b32 s10, s37, 4
  v_lshl_add_u32 v10, v181, 2, s10
  s_nop 5
  v_max3_f32 v6, v20, v21, v22
  v_max3_f32 v7, v23, v24, v25
  v_max3_f32 v6, v6, v26, v27
  v_max3_f32 v7, v7, v28, v29
  v_max3_f32 v6, v6, v30, v31
  v_max3_f32 v7, v7, v32, v33
  v_max3_f32 v6, v6, v34, v35
  v_max3_f32 v6, v6, v7, v4
  v_mov_b32 v7, v6
  s_nop 1
  v_permlane16_swap_b32 v6, v7
  s_nop 0
  v_max_f32 v6, v6, v7
  v_mov_b32 v7, v6
  s_nop 1
  v_permlane32_swap_b32 v6, v7
  s_nop 0
  v_max_f32 v6, v6, v7
  v_cmp_neq_f32 vcc, v6, v4
  v_sub_f32 v8, v4, v6
  v_mul_f32 v8, s76, v8
  v_exp_f32 v8, v8
  v_mov_b32 v4, v6
  v_mul_f32 v9, s76, v6
  v_fma_f32 v20, v20, s76, -v9
  v_fma_f32 v21, v21, s76, -v9
  v_fma_f32 v22, v22, s76, -v9
  v_fma_f32 v23, v23, s76, -v9
  v_fma_f32 v24, v24, s76, -v9
  v_fma_f32 v25, v25, s76, -v9
  v_fma_f32 v26, v26, s76, -v9
  v_fma_f32 v27, v27, s76, -v9
  v_fma_f32 v28, v28, s76, -v9
  v_fma_f32 v29, v29, s76, -v9
  v_fma_f32 v30, v30, s76, -v9
  v_fma_f32 v31, v31, s76, -v9
  v_fma_f32 v32, v32, s76, -v9
  v_fma_f32 v33, v33, s76, -v9
  v_fma_f32 v34, v34, s76, -v9
  v_fma_f32 v35, v35, s76, -v9
  v_exp_f32 v20, v20
  v_exp_f32 v21, v21
  v_exp_f32 v22, v22
  v_exp_f32 v23, v23
  v_exp_f32 v24, v24
  v_exp_f32 v25, v25
  v_exp_f32 v26, v26
  v_exp_f32 v27, v27
  v_exp_f32 v28, v28
  v_exp_f32 v29, v29
  v_exp_f32 v30, v30
  v_exp_f32 v31, v31
  v_exp_f32 v32, v32
  v_exp_f32 v33, v33
  v_exp_f32 v34, v34
  v_exp_f32 v35, v35
  v_mul_f32 v5, v5, v8
  v_cvt_pk_bf16_f32 v12, v20, v21
  v_cvt_pk_bf16_f32 v13, v22, v23
  v_cvt_pk_bf16_f32 v14, v24, v25
  v_cvt_pk_bf16_f32 v15, v26, v27
  v_cvt_pk_bf16_f32 v16, v28, v29
  v_cvt_pk_bf16_f32 v17, v30, v31
  v_cvt_pk_bf16_f32 v18, v32, v33
  v_cvt_pk_bf16_f32 v19, v34, v35
  v_add_f32 v20, v20, v21
  v_add_f32 v22, v22, v23
  v_add_f32 v24, v24, v25
  v_add_f32 v26, v26, v27
  v_add_f32 v28, v28, v29
  v_add_f32 v30, v30, v31
  v_add_f32 v32, v32, v33
  v_add_f32 v34, v34, v35
  v_add_f32 v20, v20, v22
  v_add_f32 v24, v24, v26
  v_add_f32 v28, v28, v30
  v_add_f32 v32, v32, v34
  v_add_f32 v20, v20, v24
  v_add_f32 v28, v28, v32
  v_add_f32 v20, v20, v28
  v_add_f32 v5, v5, v20
  s_mov_b32 exec_lo, 0x000f000f
  s_mov_b32 exec_hi, 0x000f000f
  ds_write_b128 v184, v[12:15] offset:15872
  ds_write_b128 v184, v[16:19] offset:16128
  s_mov_b64 exec, 15
  ds_write_b32 v10, v8 offset:128
  s_mov_b64 exec, -1
  s_add_u32 s37, s37, 2
  s_add_u32 s42, s42, 32768
  s_cmp_ge_u32 s42, 163840
  s_cselect_b32 s10, 131072, 0
  s_sub_u32 s42, s42, s10
  s_add_u32 s15, s15, 2
  s_cmp_lt_u32 s37, s36
  s_cbranch_scc1 L_kloop
  s_sub_u32 s37, s3, 1
L_vloop:
  v_add_u32 v190, s42, v3
  s_lshl_b32 s10, s37, 9
  v_add_u32 v184, s10, v185
  s_lshl_b32 s10, s37, 4
  v_and_b32 v10, 3, v1
  v_lshl_add_u32 v10, v10, 2, s10
  ds_read_b128 v[12:15], v184 offset:15872
  ds_read_b128 v[16:19], v184 offset:16128
  ds_read_b32 v8, v10 offset:128
  s_add_u32 s12, s15, 1
L_vland:
  ds_read_b32 v11, v182 offset:0
  s_add_u32 s80, s80, 1
  s_waitcnt lgkmcnt(0)
  v_readfirstlane_b32 s10, v11
  s_cmp_ge_u32 s80, 16777216
  s_cbranch_scc1 L_vland_ok
  s_cmp_ge_i32 s10, s12
  s_cbranch_scc1 L_vland_ok
  s_sleep 1
  s_branch L_vland
L_vland_ok:
  ds_read_b128 v[116:119], v190 offset:0
  ds_read_b128 v[120:123], v190 offset:1024
  ds_read_b128 v[124:127], v190 offset:2048
  ds_read_b128 v[128:131], v190 offset:3072
  ds_read_b128 v[132:135], v190 offset:4096
  ds_read_b128 v[136:139], v190 offset:5120
  ds_read_b128 v[140:143], v190 offset:6144
  ds_read_b128 v[144:147], v190 offset:7168
  ds_read_b128 v[148:151], v190 offset:8192
  ds_read_b128 v[152:155], v190 offset:9216
  ds_read_b128 v[156:159], v190 offset:10240
  ds_read_b128 v[160:163], v190 offset:11264
  ds_read_b128 v[164:167], v190 offset:12288
  ds_read_b128 v[168:171], v190 offset:13312
  ds_read_b128 v[172:175], v190 offset:14336
  ds_read_b128 v[176:179], v190 offset:15360
  v_cmp_neq_f32 vcc, 1.0, v8
  s_cbranch_vccz L_vnores
  v_mul_f32 v52, v52, v8
  v_mul_f32 v53, v53, v8
  v_mul_f32 v54, v54, v8
  v_mul_f32 v55, v55, v8
  v_mul_f32 v56, v56, v8
  v_mul_f32 v57, v57, v8
  v_mul_f32 v58, v58, v8
  v_mul_f32 v59, v59, v8
  v_mul_f32 v60, v60, v8
  v_mul_f32 v61, v61, v8
  v_mul_f32 v62, v62, v8
  v_mul_f32 v63, v63, v8
  v_mul_f32 v64, v64, v8
  v_mul_f32 v65, v65, v8
  v_mul_f32 v66, v66, v8
  v_mul_f32 v67, v67, v8
  v_mul_f32 v68, v68, v8
  v_mul_f32 v69, v69, v8
  v_mul_f32 v70, v70, v8
  v_mul_f32 v71, v71, v8
  v_mul_f32 v72, v72, v8
  v_mul_f32 v73, v73, v8
  v_mul_f32 v74, v74, v8
  v_mul_f32 v75, v75, v8
  v_mul_f32 v76, v76, v8
  v_mul_f32 v77, v77, v8
  v_mul_f32 v78, v78, v8
  v_mul_f32 v79, v79, v8
  v_mul_f32 v80, v80, v8
  v_mul_f32 v81, v81, v8
  v_mul_f32 v82, v82, v8
  v_mul_f32 v83, v83, v8
  s_nop 1
L_vnores:
  v_mov_b32 v6, s12
  s_waitcnt lgkmcnt(0)
  ds_write_b32 v2, v6 offset:24
  v_perm_b32 v84, v120, v116, s77
  v_perm_b32 v85, v128, v124, s77
  v_perm_b32 v86, v136, v132, s77
  v_perm_b32 v87, v144, v140, s77
  v_perm_b32 v88, v120, v116, s78
  v_perm_b32 v89, v128, v124, s78
  v_perm_b32 v90, v136, v132, s78
  v_perm_b32 v91, v144, v140, s78
  v_perm_b32 v92, v121, v117, s77
  v_perm_b32 v93, v129, v125, s77
  v_perm_b32 v94, v137, v133, s77
  v_perm_b32 v95, v145, v141, s77
  v_perm_b32 v96, v121, v117, s78
  v_perm_b32 v97, v129, v125, s78
  v_perm_b32 v98, v137, v133, s78
  v_perm_b32 v99, v145, v141, s78
  v_perm_b32 v100, v122, v118, s77
  v_perm_b32 v101, v130, v126, s77
  v_perm_b32 v102, v138, v134, s77
  v_perm_b32 v103, v146, v142, s77
  v_perm_b32 v104, v122, v118, s78
  v_perm_b32 v105, v130, v126, s78
  v_perm_b32 v106, v138, v134, s78
  v_perm_b32 v107, v146, v142, s78
  v_perm_b32 v108, v123, v119, s77
  v_perm_b32 v109, v131, v127, s77
  v_perm_b32 v110, v139, v135, s77
  v_perm_b32 v111, v147, v143, s77
  v_perm_b32 v112, v123, v119, s78
  v_perm_b32 v113, v131, v127, s78
  v_perm_b32 v114, v139, v135, s78
  v_perm_b32 v115, v147, v143, s78
  s_nop 1
  v_mfma_f32_16x16x32_bf16 v[52:55], v[84:87], v[12:15], v[52:55]
  v_mfma_f32_16x16x32_bf16 v[56:59], v[88:91], v[12:15], v[56:59]
  v_mfma_f32_16x16x32_bf16 v[60:63], v[92:95], v[12:15], v[60:63]
  v_mfma_f32_16x16x32_bf16 v[64:67], v[96:99], v[12:15], v[64:67]
  v_mfma_f32_16x16x32_bf16 v[68:71], v[100:103], v[12:15], v[68:71]
  v_mfma_f32_16x16x32_bf16 v[72:75], v[104:107], v[12:15], v[72:75]
  v_mfma_f32_16x16x32_bf16 v[76:79], v[108:111], v[12:15], v[76:79]
  v_mfma_f32_16x16x32_bf16 v[80:83], v[112:115], v[12:15], v[80:83]
  v_perm_b32 v84, v152, v148, s77
  v_perm_b32 v85, v160, v156, s77
  v_perm_b32 v86, v168, v164, s77
  v_perm_b32 v87, v176, v172, s77
  v_perm_b32 v88, v152, v148, s78
  v_perm_b32 v89, v160, v156, s78
  v_perm_b32 v90, v168, v164, s78
  v_perm_b32 v91, v176, v172, s78
  v_perm_b32 v92, v153, v149, s77
  v_perm_b32 v93, v161, v157, s77
  v_perm_b32 v94, v169, v165, s77
  v_perm_b32 v95, v177, v173, s77
  v_perm_b32 v96, v153, v149, s78
  v_perm_b32 v97, v161, v157, s78
  v_perm_b32 v98, v169, v165, s78
  v_perm_b32 v99, v177, v173, s78
  v_perm_b32 v100, v154, v150, s77
  v_perm_b32 v101, v162, v158, s77
  v_perm_b32 v102, v170, v166, s77
  v_perm_b32 v103, v178, v174, s77
  v_perm_b32 v104, v154, v150, s78
  v_perm_b32 v105, v162, v158, s78
  v_perm_b32 v106, v170, v166, s78
  v_perm_b32 v107, v178, v174, s78
  v_perm_b32 v108, v155, v151, s77
  v_perm_b32 v109, v163, v159, s77
  v_perm_b32 v110, v171, v167, s77
  v_perm_b32 v111, v179, v175, s77
  v_perm_b32 v112, v155, v151, s78
  v_perm_b32 v113, v163, v159, s78
  v_perm_b32 v114, v171, v167, s78
  v_perm_b32 v115, v179, v175, s78
  s_nop 1
  v_mfma_f32_16x16x32_bf16 v[52:55], v[84:87], v[16:19], v[52:55]
  v_mfma_f32_16x16x32_bf16 v[56:59], v[88:91], v[16:19], v[56:59]
  v_mfma_f32_16x16x32_bf16 v[60:63], v[92:95], v[16:19], v[60:63]
  v_mfma_f32_16x16x32_bf16 v[64:67], v[96:99], v[16:19], v[64:67]
  v_mfma_f32_16x16x32_bf16 v[68:71], v[100:103], v[16:19], v[68:71]
  v_mfma_f32_16x16x32_bf16 v[72:75], v[104:107], v[16:19], v[72:75]
  v_mfma_f32_16x16x32_bf16 v[76:79], v[108:111], v[16:19], v[76:79]
  v_mfma_f32_16x16x32_bf16 v[80:83], v[112:115], v[16:19], v[80:83]
  s_add_u32 s37, s37, 2
  s_add_u32 s42, s42, 32768
  s_cmp_ge_u32 s42, 163840
  s_cselect_b32 s10, 131072, 0
  s_sub_u32 s42, s42, s10
  s_add_u32 s15, s15, 2
  s_cmp_lt_u32 s37, s36
  s_cbranch_scc1 L_vloop
  s_cmp_eq_u32 s82, 0
  s_cbranch_scc1 L_cflush
L_slfree:
  ds_read_b32 v11, v182 offset:52
  s_add_u32 s80, s80, 1
  s_waitcnt lgkmcnt(0)
  v_readfirstlane_b32 s10, v11
  s_cmp_ge_u32 s80, 16777216
  s_cbranch_scc1 L_slfree_ok
  s_cmp_ge_i32 s10, 1
  s_cbranch_scc1 L_slfree_ok
  s_sleep 1
  s_branch L_slfree
L_slfree_ok:
L_mloop:
  v_add_u32 v190, s42, v186
  v_add_u32 v191, s42, v187
  v_add_u32 v192, s42, v188
  v_add_u32 v193, s42, v189
  v_add_u32 v184, s42, v3
  s_add_u32 s12, s15, 1
L_mland:
  ds_read_b96 v[8:10], v182 offset:0
  s_add_u32 s80, s80, 1
  s_waitcnt lgkmcnt(0)
  v_readfirstlane_b32 s37, v8
  v_readfirstlane_b32 s36, v9
  v_readfirstlane_b32 s10, v10
  s_cmp_ge_u32 s80, 16777216
  s_cbranch_scc1 L_cflush
  s_sub_u32 s36, s36, 1
  s_cmp_ge_u32 s10, s12
  s_cbranch_scc1 L_mland_ok
  s_cmp_ge_i32 s37, s12
  s_cbranch_scc1 L_mland_ok
  s_cmp_ge_u32 s36, s15
  s_cbranch_scc1 L_mland
  s_branch L_cflush
L_mland_ok:
  ds_read_b128 v[116:119], v190 offset:0
  ds_read_b128 v[120:123], v191 offset:0
  ds_read_b128 v[124:127], v192 offset:0
  ds_read_b128 v[128:131], v193 offset:0
  ds_read_b128 v[132:135], v190 offset:4096
  ds_read_b128 v[136:139], v191 offset:4096
  ds_read_b128 v[140:143], v192 offset:4096
  ds_read_b128 v[144:147], v193 offset:4096
  s_waitcnt lgkmcnt(0)
  v_mfma_f32_16x16x32_bf16 v[20:23], v[116:119], v[36:39], 0
  v_mfma_f32_16x16x32_bf16 v[24:27], v[132:135], v[36:39], 0
  v_mfma_f32_16x16x32_bf16 v[20:23], v[120:123], v[40:43], v[20:23]
  v_mfma_f32_16x16x32_bf16 v[24:27], v[136:139], v[40:43], v[24:27]
  v_mfma_f32_16x16x32_bf16 v[20:23], v[124:127], v[44:47], v[20:23]
  v_mfma_f32_16x16x32_bf16 v[24:27], v[140:143], v[44:47], v[24:27]
  v_mfma_f32_16x16x32_bf16 v[20:23], v[128:131], v[48:51], v[20:23]
  v_mfma_f32_16x16x32_bf16 v[24:27], v[144:147], v[48:51], v[24:27]
  s_nop 7
  v_max3_f32 v6, v20, v21, v22
  v_max3_f32 v7, v23, v24, v25
  v_max3_f32 v6, v6, v26, v27
  v_max3_f32 v6, v6, v7, v4
  v_mov_b32 v7, v6
  s_nop 1
  v_permlane16_swap_b32 v6, v7
  s_nop 0
  v_max_f32 v6, v6, v7
  v_mov_b32 v7, v6
  s_nop 1
  v_permlane32_swap_b32 v6, v7
  s_nop 0
  v_max_f32 v6, v6, v7
  v_cmp_neq_f32 vcc, v6, v4
  v_sub_f32 v8, v4, v6
  v_mul_f32 v8, s76, v8
  v_exp_f32 v8, v8
  v_mov_b32 v4, v6
  v_mul_f32 v9, s76, v6
  v_fma_f32 v20, v20, s76, -v9
  v_fma_f32 v21, v21, s76, -v9
  v_fma_f32 v22, v22, s76, -v9
  v_fma_f32 v23, v23, s76, -v9
  v_fma_f32 v24, v24, s76, -v9
  v_fma_f32 v25, v25, s76, -v9
  v_fma_f32 v26, v26, s76, -v9
  v_fma_f32 v27, v27, s76, -v9
  v_exp_f32 v20, v20
  v_exp_f32 v21, v21
  v_exp_f32 v22, v22
  v_exp_f32 v23, v23
  v_exp_f32 v24, v24
  v_exp_f32 v25, v25
  v_exp_f32 v26, v26
  v_exp_f32 v27, v27
  v_mul_f32 v5, v5, v8
  v_cvt_pk_bf16_f32 v12, v20, v21
  v_cvt_pk_bf16_f32 v13, v22, v23
  v_cvt_pk_bf16_f32 v14, v24, v25
  v_cvt_pk_bf16_f32 v15, v26, v27
  v_add_f32 v20, v20, v21
  v_add_f32 v22, v22, v23
  v_add_f32 v24, v24, v25
  v_add_f32 v26, v26, v27
  v_add_f32 v20, v20, v22
  v_add_f32 v24, v24, v26
  v_add_f32 v20, v20, v24
  v_add_f32 v5, v5, v20
  s_cbranch_vccz L_mnores
  v_mul_f32 v52, v52, v8
  v_mul_f32 v53, v53, v8
  v_mul_f32 v54, v54, v8
  v_mul_f32 v55, v55, v8
  v_mul_f32 v56, v56, v8
  v_mul_f32 v57, v57, v8
  v_mul_f32 v58, v58, v8
  v_mul_f32 v59, v59, v8
  v_mul_f32 v60, v60, v8
  v_mul_f32 v61, v61, v8
  v_mul_f32 v62, v62, v8
  v_mul_f32 v63, v63, v8
  v_mul_f32 v64, v64, v8
  v_mul_f32 v65, v65, v8
  v_mul_f32 v66, v66, v8
  v_mul_f32 v67, v67, v8
  v_mul_f32 v68, v68, v8
  v_mul_f32 v69, v69, v8
  v_mul_f32 v70, v70, v8
  v_mul_f32 v71, v71, v8
  v_mul_f32 v72, v72, v8
  v_mul_f32 v73, v73, v8
  v_mul_f32 v74, v74, v8
  v_mul_f32 v75, v75, v8
  v_mul_f32 v76, v76, v8
  v_mul_f32 v77, v77, v8
  v_mul_f32 v78, v78, v8
  v_mul_f32 v79, v79, v8
  v_mul_f32 v80, v80, v8
  v_mul_f32 v81, v81, v8
  v_mul_f32 v82, v82, v8
  v_mul_f32 v83, v83, v8
  s_nop 1
L_mnores:
  s_cmp_ge_i32 s37, s12
  s_cbranch_scc1 L_mv_ok
L_mv:
  ds_read_b32 v11, v182 offset:0
  s_add_u32 s80, s80, 1
  s_waitcnt lgkmcnt(0)
  v_readfirstlane_b32 s10, v11
  s_cmp_ge_u32 s80, 16777216
  s_cbranch_scc1 L_mv_ok
  s_cmp_ge_i32 s10, s12
  s_cbranch_scc1 L_mv_ok
  s_branch L_mv
L_mv_ok:
  ds_read_b128 v[148:151], v184 offset:8192
  ds_read_b128 v[152:155], v184 offset:9216
  ds_read_b128 v[156:159], v184 offset:10240
  ds_read_b128 v[160:163], v184 offset:11264
  ds_read_b128 v[164:167], v184 offset:12288
  ds_read_b128 v[168:171], v184 offset:13312
  ds_read_b128 v[172:175], v184 offset:14336
  ds_read_b128 v[176:179], v184 offset:15360
  v_mov_b32 v6, s12
  s_waitcnt lgkmcnt(0)
  ds_write_b32 v2, v6 offset:24
  v_perm_b32 v84, v152, v148, s77
  v_perm_b32 v85, v160, v156, s77
  v_perm_b32 v86, v168, v164, s77
  v_perm_b32 v87, v176, v172, s77
  v_perm_b32 v88, v152, v148, s78
  v_perm_b32 v89, v160, v156, s78
  v_perm_b32 v90, v168, v164, s78
  v_perm_b32 v91, v176, v172, s78
  v_mfma_f32_16x16x32_bf16 v[52:55], v[84:87], v[12:15], v[52:55]
  v_perm_b32 v92, v153, v149, s77
  v_perm_b32 v93, v161, v157, s77
  v_perm_b32 v94, v169, v165, s77
  v_perm_b32 v95, v177, v173, s77
  v_mfma_f32_16x16x32_bf16 v[56:59], v[88:91], v[12:15], v[56:59]
  v_perm_b32 v96, v153, v149, s78
  v_perm_b32 v97, v161, v157, s78
  v_perm_b32 v98, v169, v165, s78
  v_perm_b32 v99, v177, v173, s78
  v_mfma_f32_16x16x32_bf16 v[60:63], v[92:95], v[12:15], v[60:63]
  v_perm_b32 v100, v154, v150, s77
  v_perm_b32 v101, v162, v158, s77
  v_perm_b32 v102, v170, v166, s77
  v_perm_b32 v103, v178, v174, s77
  v_mfma_f32_16x16x32_bf16 v[64:67], v[96:99], v[12:15], v[64:67]
  v_perm_b32 v104, v154, v150, s78
  v_perm_b32 v105, v162, v158, s78
  v_perm_b32 v106, v170, v166, s78
  v_perm_b32 v107, v178, v174, s78
  v_mfma_f32_16x16x32_bf16 v[68:71], v[100:103], v[12:15], v[68:71]
  v_perm_b32 v108, v155, v151, s77
  v_perm_b32 v109, v163, v159, s77
  v_perm_b32 v110, v171, v167, s77
  v_perm_b32 v111, v179, v175, s77
  v_mfma_f32_16x16x32_bf16 v[72:75], v[104:107], v[12:15], v[72:75]
  v_perm_b32 v112, v155, v151, s78
  v_perm_b32 v113, v163, v159, s78
  v_perm_b32 v114, v171, v167, s78
  v_perm_b32 v115, v179, v175, s78
  v_mfma_f32_16x16x32_bf16 v[76:79], v[108:111], v[12:15], v[76:79]
  s_nop 1
  v_mfma_f32_16x16x32_bf16 v[80:83], v[112:115], v[12:15], v[80:83]
  s_add_u32 s42, s42, 32768
  s_cmp_ge_u32 s42, 163840
  s_cselect_b32 s10, 131072, 0
  s_sub_u32 s42, s42, s10
  s_add_u32 s15, s15, 2
  s_cmp_ge_u32 s36, s15
  s_cbranch_scc1 L_mloop
L_cflush:
  v_mov_b32 v7, v5
  v_mul_u32_u24 v6, 528, v181
  v_lshl_add_u32 v6, v180, 7, v6
  v_permlane16_swap_b32 v5, v7
  s_sub_u32 s11, s3, 1
  v_add_f32 v5, v5, v7
  v_mov_b32 v7, v5
  s_mul_i32 s10, s11, 2176
  v_add_u32 v6, s10, v6
  v_permlane32_swap_b32 v5, v7
  s_lshl_b32 s10, s11, 3
  v_add_f32 v5, v5, v7
  v_lshlrev_b32 v7, 4, v181
  v_add_u32 v7, s10, v7
  s_mov_b32 exec_lo, 0x000f000f
  s_mov_b32 exec_hi, 0x000f000f
  ds_write_b128 v6, v[52:55] offset:2688
  ds_write_b128 v6, v[56:59] offset:2704
  ds_write_b128 v6, v[60:63] offset:2720
  ds_write_b128 v6, v[64:67] offset:2736
  ds_write_b128 v6, v[68:71] offset:2752
  ds_write_b128 v6, v[72:75] offset:2768
  ds_write_b128 v6, v[76:79] offset:2784
  ds_write_b128 v6, v[80:83] offset:2800
  s_mov_b64 exec, 15
  ds_write_b64 v7, v[4:5] offset:64
  s_mov_b64 exec, 1
  ds_add_u32 v182, v183 offset:32
  s_mov_b64 exec, -1
  s_cmp_lg_u32 s82, 0
  s_cbranch_scc1 L_end
  s_mov_b32 s82, 1
  s_mov_b32 s36, 30
  s_waitcnt lgkmcnt(0)
  s_branch L_cprob
L_end:
  s_endpgm
.section .rodata,"a"
.p2align 6
.amdhsa_kernel concat_heads__gqa_block_cached__gqa_block_cached__decode_kernel
  .amdhsa_next_free_vgpr 256
  .amdhsa_next_free_sgpr 102
  .amdhsa_accum_offset 256
  .amdhsa_group_segment_fixed_size 0
  .amdhsa_kernarg_size 104
  .amdhsa_user_sgpr_count 2
  .amdhsa_user_sgpr_kernarg_segment_ptr 1
  .amdhsa_system_sgpr_workgroup_id_x 1
.end_amdhsa_kernel
```
